```python
import torch

def _softmax(x, axis=-1):
    return torch.softmax(x, dim=axis)
def _gelu(x):
    return torch.nn.functional.gelu(x, approximate="tanh")
def _silu(x):
    return torch.nn.functional.silu(x)
def _sigmoid(x):
    return torch.sigmoid(x)
def _layernorm(x, axis=-1, eps=1e-5):
    m = x.mean(dim=axis, keepdim=True)
    v = x.var(dim=axis, keepdim=True, unbiased=False)
    return (x - m) / torch.sqrt(v + eps)
def _scatter_add(tgt, idx, src, axis=0):
    return tgt.clone().index_add_(axis, idx, src)
def _segment_sum(src, seg, n):
    out = torch.zeros((n,) + src.shape[1:], dtype=src.dtype)
    return out.index_add_(0, seg, src)
def _pad(x, pw):
    flat = tuple(v for pair in reversed(pw) for v in pair)
    return torch.nn.functional.pad(x, flat)

kernel_name = 'concat_heads__ssm_conv_h3__sliding_local_dilated__prompt'

def setup_inputs():

    _w = (lambda a: (lambda t: t.to(torch.bfloat16) if t.is_floating_point() else t)(torch.as_tensor(a)))
    def _A_setup():
        B, S, D = 1, 2048, 576
        ks = 4
        return {
            "q": _w((lambda *s: torch.randn(*s, dtype=torch.bfloat16) * 0.05)(B, S, D)),
            "k": _w((lambda *s: torch.randn(*s, dtype=torch.bfloat16) * 0.8)(B, S, D)),
            "v": _w((lambda *s: torch.randn(*s, dtype=torch.bfloat16) * 0.8)(B, S, D)),
            "shift_k": _w((lambda *s: torch.randn(*s, dtype=torch.bfloat16) * 0.8)(D, ks) * 0.5),
            "ssm_k": _w((lambda *s: torch.randn(*s, dtype=torch.bfloat16) * 1.6)(D, S) * (1.0 / S ** 0.5)),
            "ssm_D": _w((lambda *s: torch.randn(*s, dtype=torch.bfloat16) * 0.8)(D)),
        }
    _A_in = _A_setup()

    def _B_setup():
        B, S, D = 1, 2048, 576
        return {
            "x": _w((lambda *s: torch.randn(*s, dtype=torch.bfloat16) * 0.2)(B, S, D)),
            "wqkv": _w((lambda *s: torch.randn(*s, dtype=torch.bfloat16) * 0.2)(D, 3 * D)),
            "wo": _w((lambda *s: torch.randn(*s, dtype=torch.bfloat16) * 0.05)(D, D)),
        }
    _B_in = _B_setup()

    return {
        "A_q": _A_in["q"],
        "A_k": _A_in["k"],
        "A_v": _A_in["v"],
        "A_shift_k": _A_in["shift_k"],
        "A_ssm_k": _A_in["ssm_k"],
        "A_ssm_D": _A_in["ssm_D"],
        "B_x": _B_in["x"],
        "B_wqkv": _B_in["wqkv"],
        "B_wo": _B_in["wo"],
    }

def reference(A_q, A_k, A_v, A_shift_k, A_ssm_k, A_ssm_D, B_x, B_wqkv, B_wo):
    def _A_ref(q, k, v, shift_k, ssm_k, ssm_D):
        B, S, D = q.shape
        ks = shift_k.shape[-1]
        k_pad = _pad(k, ((0, 0), (ks - 1, 0), (0, 0)))
        k_shift = torch.zeros_like(k)
        for t in range(ks):
            k_shift = k_shift + k_pad[:, t:t + S, :] * shift_k[:, ks - 1 - t][None, None, :]
        kv = k_shift * v
        L = 2 * S
        kv_pad = _pad(kv, ((0, 0), (0, S), (0, 0)))
        kf_pad = _pad(ssm_k, ((0, 0), (0, S)))
        kv_f = (lambda x, axes=(-2,-1): torch.fft.rfft2(x.float(), dim=axes))(kv_pad[:, None, :, :], axes=(1, 2))
        kf_f = (lambda x, axes=(-2,-1): torch.fft.rfft2(x.float(), dim=axes))(kf_pad[:, None, :], axes=(1, 2))
        kf_f = (lambda x, *d: x.permute(*d))(kf_f, 1, 2, 0)
        y_f = kv_f * kf_f[None, :, :, :]
        y = (lambda x, s, axes=(-2,-1): torch.fft.irfft2(x, s=s, dim=axes).to(torch.bfloat16))(y_f, (1, L), axes=(1, 2))[:, 0, :S, :]
        y = y + kv * ssm_D[None, None, :]
        return q * y

    def _B_ref(x, wqkv, wo):
        B, S, D = x.shape
        H = 32; Dh = D // H
        W, dil = 8, 2
        qkv = (lambda x, *d: x.permute(*d))((x @ wqkv).reshape(B, S, 3, H, Dh), 2, 0, 3, 1, 4)
        q, k, v = qkv[0], qkv[1], qkv[2]
        scale = Dh ** -0.5
        pos = torch.arange(S)
        off = torch.arange(W) * dil
        idx = pos[:, None] - off[None, :]
        mask = idx >= 0
        idx_c = torch.where(mask, idx, 0).reshape(-1)
        kg = k[:, :, idx_c, :].reshape(B, H, S, W, Dh)
        vg = v[:, :, idx_c, :].reshape(B, H, S, W, Dh)
        logits = torch.einsum("bhsd,bhswd->bhsw", q, kg) * scale
        logits = torch.where(mask[None, None, :, :], logits, -1e9)
        attn = _softmax(logits, axis=-1)
        o = torch.einsum("bhsw,bhswd->bhsd", attn, vg)
        return (lambda x, *d: x.permute(*d))(o, 0, 2, 1, 3).reshape(B, S, D) @ wo

    a = _A_ref(A_q, A_k, A_v, A_shift_k, A_ssm_k, A_ssm_D)
    b = _B_ref(B_x, B_wqkv, B_wo)
    return torch.concatenate([a, b], axis=-1)
```

```asm
; @launch grid=(256,1,1) block=(512,1,1) lds=163840
.amdgcn_target "amdgcn-amd-amdhsa--gfx950"
.text
.globl concat_heads__ssm_conv_h3__sliding_local_dilated__prompt_kernel
.p2align 8
.type concat_heads__ssm_conv_h3__sliding_local_dilated__prompt_kernel,@function
concat_heads__ssm_conv_h3__sliding_local_dilated__prompt_kernel:
    s_cmp_ge_u32 s2, 256
    s_cbranch_scc1 L_end
    s_load_dwordx16 s[4:19], s[0:1], 0
    s_load_dwordx8 s[20:27], s[0:1], 64
    v_and_b32 v1, 63, v0
    v_lshrrev_b32 v2, 6, v0
    s_getreg_b32 s57, hwreg(HW_REG_XCC_ID)
    v_readfirstlane_b32 s56, v2
    s_and_b32 s57, s57, 7
    s_mov_b32 s60, 0
    s_bitcmp1_b32 s2, 7
    s_cbranch_scc1 L_roleA
    s_and_b32 s64, s2, 7
    s_bfe_u32 s65, s2, 0x40003
    s_and_b32 s66, s56, 3
    s_lshr_b32 s69, s56, 2
    s_lshl_b32 s61, s64, 8
    s_lshl_b32 s62, s66, 6
    s_add_u32 s62, s62, s61
    s_movk_i32 s3, 1152
    v_lshrrev_b32 v224, 3, v1
    v_and_b32 v225, 7, v1
    v_lshrrev_b32 v226, 4, v1
    v_add_u32 v227, s62, v224
    v_mul_i32_i24 v227, s3, v227
    v_xor_b32 v228, v225, v226
    v_lshl_add_u32 v2, v228, 4, v227
    v_xor_b32 v3, 64, v2
    v_add_u32 v3, 8192, v3
    v_add_u32 v4, 16384, v2
    v_add_u32 v5, 16384, v3
    s_lshl_b32 s62, s66, 3
    s_add_u32 s62, s62, s61
    s_sub_u32 s62, s62, 16
    v_add_u32 v227, s62, v224
    v_mul_i32_i24 v227, s3, v227
    s_lshl_b32 s62, s66, 2
    v_xor_b32 v228, s62, v228
    v_and_b32 v228, 7, v228
    v_lshl_add_u32 v6, v228, 4, v227
    s_mul_i32 s63, s65, 72
    s_and_b32 s61, s65, 1
    s_lshl_b32 s61, s61, 3
    s_sub_u32 s63, s63, s61
    s_lshl_b32 s62, s66, 7
    v_add_u32 v224, s62, v1
    v_mul_u32_u24 v225, 4370, v224
    v_lshrrev_b32 v225, 16, v225
    v_mul_u32_u24 v226, 15, v225
    v_sub_u32 v226, v224, v226
    v_mul_u32_u24 v227, 52, v226
    v_lshrrev_b32 v227, 8, v227
    v_mul_u32_u24 v228, 1072, v227
    v_lshl_add_u32 v228, v226, 4, v228
    v_and_b32 v226, 24, v225
    v_and_b32 v227, 1, v225
    v_lshl_add_u32 v226, v227, 2, v226
    v_bfe_u32 v227, v225, 1, 2
    v_add_u32 v226, v226, v227
    v_mul_u32_u24 v226, 3456, v226
    v_add3_u32 v7, v226, v228, s63
    v_add_u32 v224, s62, v1
    v_add_u32 v224, 64, v224
    v_mul_u32_u24 v225, 4370, v224
    v_lshrrev_b32 v225, 16, v225
    v_mul_u32_u24 v226, 15, v225
    v_sub_u32 v226, v224, v226
    v_mul_u32_u24 v227, 52, v226
    v_lshrrev_b32 v227, 8, v227
    v_mul_u32_u24 v228, 1072, v227
    v_lshl_add_u32 v228, v226, 4, v228
    v_and_b32 v226, 24, v225
    v_and_b32 v227, 1, v225
    v_lshl_add_u32 v226, v227, 2, v226
    v_bfe_u32 v227, v225, 1, 2
    v_add_u32 v226, v226, v227
    v_mul_u32_u24 v226, 3456, v226
    v_add3_u32 v8, v226, v228, s63
    v_add_u32 v8, -1024, v8
    v_mov_b32 v227, 1073741824
    v_cmp_lt_u32 vcc, 479, v224
    s_nop 1
    v_cndmask_b32 v8, v8, v227, vcc
    s_lshl_b32 s62, s65, 3
    s_add_u32 s62, s62, s56
    s_lshl_b32 s3, s62, 12
    v_lshlrev_b32 v216, 7, v1
    v_add_u32 v216, s3, v216
    s_mul_i32 s62, s62, 5
    v_add_u32 v225, s62, v1
    v_lshrrev_b32 v226, 1, v225
    v_mul_u32_u24 v226, 896, v226
    v_lshl_add_u32 v226, v225, 7, v226
    s_mul_i32 s3, s64, 294912
    s_sub_u32 s3, s3, 18432
    v_add_u32 v217, s3, v226
    s_lshl_b32 s3, s64, 7
    s_add_u32 s3, s3, 7077888
    s_cmp_lt_u32 s66, 2
    s_cselect_b64 vcc, -1, 0
    s_lshl_b32 s67, s66, 11
    s_lshl_b32 s63, s66, 10
    s_waitcnt lgkmcnt(0)
    s_mov_b32 s32, s18
    s_mov_b32 s33, s19
    s_mov_b32 s34, 1990656
    s_mov_b32 s35, 0x20000
    s_mov_b32 s28, s16
    s_mov_b32 s29, s17
    s_mov_b32 s30, 2359296
    s_mov_b32 s31, 0x20000
    s_mov_b64 exec, 0x1f
    buffer_load_dword v218, v217, s[28:31], 0 offen
    s_mov_b32 exec_lo, -1
    buffer_load_dword v218, v216, s[32:35], 0 offen
    s_mov_b64 exec, -1
    s_mov_b32 s7, s67
    s_lshl_b32 s6, s66, 13
    s_add_u32 s6, s6, 2048
    s_mov_b64 s[8:9], vcc
    s_mov_b32 s44, s26
    s_mov_b32 s45, s27
    s_mov_b32 s46, 16777216
    s_mov_b32 s47, 0x20000
    s_mov_b32 s36, s20
    s_mov_b32 s37, s21
    s_mov_b32 s38, 663552
    s_mov_b32 s39, 0x20000
    s_mov_b32 s40, s22
    s_mov_b32 s41, s23
    s_mov_b32 s42, 4718592
    s_mov_b32 s43, 0x20000
    s_mov_b32 s22, s3
    s_lshl_b32 s5, s66, 10
    s_lshl_b32 s4, s66, 8
    v_lshrrev_b32 v224, 2, v1
    v_and_b32 v225, 3, v1
    v_mul_u32_u24 v226, 480, v224
    s_add_u32 s61, s61, 104448
    v_add_u32 v226, s61, v226
    v_lshl_add_u32 v228, v225, 3, v226
    s_mul_i32 s62, s69, 40
    v_add_u32 v9, s62, v228
    v_min_u32 v227, 2, v225
    v_mul_u32_u24 v227, 80, v227
    v_add3_u32 v227, v226, v227, 32
    s_mul_i32 s62, s66, 40
    s_add_u32 s62, s62, 80
    v_add_u32 v228, s62, v228
    s_cmp_eq_u32 s69, 0
    s_cselect_b64 vcc, -1, 0
    v_cndmask_b32 v10, v228, v227, vcc
    v_and_b32 v227, 15, v1
    v_lshrrev_b32 v228, 4, v1
    v_lshrrev_b32 v226, 1, v227
    v_xor_b32 v226, v228, v226
    v_lshlrev_b32 v226, 4, v226
    v_lshl_add_u32 v182, v227, 7, v226
    v_xor_b32 v183, 64, v182
    v_add_u32 v180, s6, v182
    v_add_u32 v181, s6, v183
    v_add_u32 v184, 69632, v180
    v_add_u32 v185, 69632, v181
    v_add_u32 v186, 69632, v182
    v_add_u32 v187, 69632, v183
    v_mul_u32_u24 v226, 288, v224
    v_lshl_add_u32 v205, v225, 3, v226
    v_add_u32 v206, 137216, v205
    v_lshlrev_b32 v226, 3, v224
    v_lshl_add_u32 v213, v225, 7, v226
    s_lshl_b32 s62, s69, 10
    s_add_u32 s3, s62, 70144
    v_add_u32 v213, s3, v213
    s_add_u32 s3, s7, 79872
    v_add_u32 v212, s3, v226
    v_lshlrev_b32 v224, 3, v1
    v_and_b32 v225, 0x78, v224
    s_lshl_b32 s61, s69, 2
    v_add3_u32 v211, v225, s3, 0
    v_add_u32 v211, s61, v211
    v_add_u32 v209, s3, v224
    s_add_u32 s62, s62, s7
    s_add_u32 s62, s62, 69632
    v_add_u32 v208, s62, v224
    s_and_b32 s61, s66, 1
    s_lshl_b32 s61, s61, 10
    s_lshr_b32 s62, s66, 1
    s_lshl_b32 s62, s62, 9
    s_add_u32 s61, s61, s62
    s_cmp_eq_u32 s66, 0
    s_cselect_b32 s62, 0, 8704
    s_add_u32 s62, s62, 10240
    s_cmp_eq_u32 s69, 0
    s_cselect_b32 s61, s62, s61
    s_add_u32 s61, s61, 69632
    v_add_u32 v210, s61, v224
    v_and_b32 v226, 1, v227
    v_lshl_add_u32 v229, v228, 2, v226
    v_cmp_eq_u32 s[10:11], 1, v226
    v_cmp_ge_u32 s[12:13], v227, v229
    v_add_u32 v229, 2, v229
    v_cmp_ge_u32 s[14:15], v227, v229
    v_mov_b32 v226, 0x0c0c0100
    v_mov_b32 v224, 0x01000c0c
    v_mov_b32 v225, 0x0c0c0c0c
    v_cndmask_b32 v226, v226, v224, s[10:11]
    v_cndmask_b32 v192, v226, v225, s[12:13]
    v_cndmask_b32 v194, v225, v226, s[12:13]
    v_mov_b32 v226, 0x0c0c0302
    v_mov_b32 v224, 0x03020c0c
    v_cndmask_b32 v226, v226, v224, s[10:11]
    v_cndmask_b32 v193, v226, v225, s[14:15]
    v_cndmask_b32 v195, v225, v226, s[14:15]
    s_or_b32 s62, s64, s66
    s_cmp_eq_u32 s62, 0
    s_cselect_b64 s[16:17], s[12:13], -1
    s_cselect_b64 s[18:19], s[14:15], -1
    s_mov_b32 s20, 0x3eae1a93
    v_mov_b32 v199, 0xcf7ce18f
    v_mov_b32 v234, 0
    v_mov_b32 v235, 0
    v_mov_b32 v238, 0
    v_mov_b32 v239, 0
    v_mov_b32 v242, 0
    v_mov_b32 v243, 0
    v_mov_b32 v246, 0
    v_mov_b32 v247, 0
    v_mov_b32 v159, 0
    v_mov_b32 v163, 0
    v_mov_b32 v167, 0
    v_mov_b32 v171, 0
    v_mov_b32 v175, 0
    s_mov_b32 s21, 0x3eae1a93
    s_and_b32 s61, s65, 1
    s_lshl_b32 s61, s61, 3
    s_add_u32 s61, s61, s56
    s_lshl_b32 s62, s64, 9
    s_add_u32 s62, s62, 7147520
    s_lshr_b32 s3, s61, 2
    s_lshl_b32 s3, s3, 7
    s_add_u32 s3, s3, s62
    v_and_b32 v226, 31, v1
    v_lshlrev_b32 v226, 2, v226
    v_add_u32 v198, s3, v226
    s_lshl_b32 s3, s66, 7
    s_add_u32 s62, s62, s3
    s_lshl_b32 s3, s69, 6
    s_add_u32 s62, s62, s3
    s_lshl_b32 s3, s65, 2
    s_add_u32 s62, s62, s3
    v_mov_b32 v197, s62
    s_lshl_b32 s3, s64, 4
    s_add_u32 s61, s61, s3
    s_mul_i32 s3, s61, 18432
    s_add_u32 s3, s3, 4718592
    v_lshlrev_b32 v229, 4, v1
    v_add_u32 v202, s3, v229
    s_mul_i32 s61, s61, 36864
    s_lshr_b32 s3, s65, 1
    s_mul_i32 s25, s3, 144
    s_add_u32 s3, s25, 1152
    s_add_u32 s3, s3, s61
    v_add_u32 v224, 0, v1
    v_mul_u32_u24 v226, 7282, v224
    v_lshrrev_b32 v226, 16, v226
    v_mul_u32_u24 v226, 2160, v226
    v_lshl_add_u32 v226, v224, 4, v226
    v_add_u32 v203, s3, v226
    v_add_u32 v224, 64, v1
    v_mul_u32_u24 v226, 7282, v224
    v_lshrrev_b32 v226, 16, v226
    v_mul_u32_u24 v226, 2160, v226
    v_lshl_add_u32 v226, v224, 4, v226
    v_add_u32 v204, s3, v226
    v_add_u32 v224, 128, v1
    v_mul_u32_u24 v226, 7282, v224
    v_lshrrev_b32 v226, 16, v226
    v_mul_u32_u24 v226, 2160, v226
    v_lshl_add_u32 v226, v224, 4, v226
    v_add_u32 v219, s3, v226
    s_mul_i32 s3, s56, 2304
    s_add_u32 s3, s3, 69632
    v_add_u32 v230, s3, v229
    v_mul_u32_u24 v226, 144, v227
    v_lshl_add_u32 v226, v228, 3, v226
    v_add_u32 v231, s3, v226
    s_lshl_b32 s61, s64, 11
    s_add_u32 s61, s61, 7081984
    s_lshl_b32 s23, s65, 7
    s_add_u32 s23, s23, s61
    v_lshlrev_b32 v226, 7, v227
    v_add_u32 v196, s61, v226
    s_lshl_b32 s3, s64, 2
    s_add_u32 s3, s3, s66
    s_mul_i32 s3, s3, 73728
    s_add_u32 s3, s3, 4718592
    s_lshl_b32 s61, s65, 10
    s_lshl_b32 s62, s69, 3
    s_add_u32 s61, s61, s62
    s_add_u32 s61, s61, s3
    v_add_u32 v214, s61, v229
    s_lshr_b32 s61, s65, 1
    s_lshl_b32 s61, s61, 8
    s_add_u32 s3, s3, s61
    s_and_b32 s61, s65, 1
    s_lshl_b32 s61, s61, 3
    s_add_u32 s3, s3, s61
    s_lshl_b32 s61, s69, 2
    s_add_u32 s3, s3, s61
    s_add_u32 s3, s3, 16384
    v_mul_u32_u24 v215, 18176, v228
    v_add3_u32 v215, v215, s3, v229
    s_lshl_b32 s62, s66, 6
    v_add_u32 v224, s62, v1
    v_mul_u32_u24 v225, 7282, v224
    v_lshrrev_b32 v225, 16, v225
    v_mul_u32_u24 v226, 9, v225
    v_sub_u32 v226, v224, v226
    v_lshlrev_b32 v226, 4, v226
    v_add_u32 v226, s25, v226
    v_bfe_u32 v227, v225, 1, 2
    v_and_b32 v228, 1, v225
    v_lshrrev_b32 v229, 5, v225
    v_bfe_u32 v224, v225, 3, 2
    v_lshl_add_u32 v188, v224, 2, v227
    v_mad_u32_u24 v188, v228, 20, v188
    v_mad_u32_u24 v188, v229, 36, v188
    v_mul_u32_u24 v188, 1152, v188
    v_add_u32 v188, v188, v226
    v_lshrrev_b32 v224, 3, v225
    v_lshl_add_u32 v224, v224, 1, v228
    v_mad_u32_u24 v224, v224, 36, v227
    v_add_u32 v224, 16, v224
    v_mul_u32_u24 v224, 1152, v224
    v_add_u32 v191, v224, v226
    s_lshl_b32 s62, s66, 6
    s_add_u32 s62, s62, 256
    v_add_u32 v224, s62, v1
    v_mul_u32_u24 v225, 7282, v224
    v_lshrrev_b32 v225, 16, v225
    v_mul_u32_u24 v226, 9, v225
    v_sub_u32 v226, v224, v226
    v_lshlrev_b32 v226, 4, v226
    v_add_u32 v226, s25, v226
    v_bfe_u32 v227, v225, 1, 2
    v_and_b32 v228, 1, v225
    v_lshrrev_b32 v229, 5, v225
    v_bfe_u32 v224, v225, 3, 2
    v_lshl_add_u32 v189, v224, 2, v227
    v_mad_u32_u24 v189, v228, 20, v189
    v_mad_u32_u24 v189, v229, 36, v189
    v_mul_u32_u24 v189, 1152, v189
    v_add_u32 v189, v189, v226
    v_lshrrev_b32 v224, 3, v225
    v_lshl_add_u32 v224, v224, 1, v228
    v_mad_u32_u24 v224, v224, 36, v227
    v_add_u32 v224, 16, v224
    v_mul_u32_u24 v224, 1152, v224
    v_add_u32 v176, v224, v226
    s_lshl_b32 s62, s66, 4
    s_add_u32 s62, s62, 512
    v_add_u32 v224, s62, v1
    v_mul_u32_u24 v225, 7282, v224
    v_lshrrev_b32 v225, 16, v225
    v_mul_u32_u24 v226, 9, v225
    v_sub_u32 v226, v224, v226
    v_lshlrev_b32 v226, 4, v226
    v_add_u32 v226, s25, v226
    v_bfe_u32 v227, v225, 1, 2
    v_and_b32 v228, 1, v225
    v_lshrrev_b32 v229, 5, v225
    v_bfe_u32 v224, v225, 3, 2
    v_lshl_add_u32 v190, v224, 2, v227
    v_mad_u32_u24 v190, v228, 20, v190
    v_mad_u32_u24 v190, v229, 36, v190
    v_mul_u32_u24 v190, 1152, v190
    v_add_u32 v190, v190, v226
    v_lshrrev_b32 v224, 3, v225
    v_lshl_add_u32 v224, v224, 1, v228
    v_mad_u32_u24 v224, v224, 36, v227
    v_add_u32 v224, 16, v224
    v_mul_u32_u24 v224, 1152, v224
    v_add_u32 v177, v224, v226
    s_mov_b64 vcc, s[8:9]
    s_cmp_lg_u32 s69, 0
    s_cbranch_scc1 L_r1_2
    s_add_u32 m0, s7, 104448
    s_mov_b32 s67, 0
    buffer_load_dwordx4 v7, s[32:35], s67 offen offset:0 lds
    s_add_u32 m0, s7, 112640
    s_mov_b32 s67, 110592
    buffer_load_dwordx4 v7, s[32:35], s67 offen offset:0 lds
    s_branch L_rj_3
L_r1_2:
    s_add_u32 m0, s7, 104448
    s_mov_b32 s67, 0
    buffer_load_dwordx4 v8, s[32:35], s67 offen offset:1024 lds
    s_add_u32 m0, s6, 0
    s_mov_b32 s68, 0
    buffer_load_dwordx4 v2, s[28:31], s68 offen offset:0 lds
    buffer_load_dwordx4 v3, s[28:31], s68 offen offset:1024 lds
    buffer_load_dwordx4 v4, s[28:31], s68 offen offset:2048 lds
    buffer_load_dwordx4 v5, s[28:31], s68 offen offset:3072 lds
    s_cbranch_vccz L_nh_1
    s_add_u32 m0, s63, 0
    s_nop 0
    buffer_load_dwordx4 v6, s[28:31], s68 offen lds
L_nh_1:
    s_add_u32 m0, s6, 4096
    s_mov_b32 s68, 36864
    buffer_load_dwordx4 v2, s[28:31], s68 offen offset:0 lds
    buffer_load_dwordx4 v3, s[28:31], s68 offen offset:1024 lds
    buffer_load_dwordx4 v4, s[28:31], s68 offen offset:2048 lds
    buffer_load_dwordx4 v5, s[28:31], s68 offen offset:3072 lds
    s_add_u32 m0, s7, 112640
    s_mov_b32 s67, 110592
    buffer_load_dwordx4 v8, s[32:35], s67 offen offset:1024 lds
L_rj_3:
    s_cmp_lg_u32 s69, 0
    s_cbranch_scc1 L_kl1_4
    s_add_u32 m0, s7, 120832
    s_mov_b32 s67, 221184
    buffer_load_dwordx4 v7, s[32:35], s67 offen offset:0 lds
    s_add_u32 m0, s7, 129024
    s_mov_b32 s67, 331776
    buffer_load_dwordx4 v7, s[32:35], s67 offen offset:0 lds
    v_mov_b32 v201, 0
    buffer_load_dword v200, v201, s[44:47], s22 offen sc1
    s_waitcnt vmcnt(3)
    s_barrier
    ds_read_b128 v[116:119], v180 offset:0
    ds_read_b64_tr_b16 v[84:85], v9 offset:80
    ds_read_b64_tr_b16 v[86:87], v9 offset:320
    ds_read_b128 v[120:123], v180 offset:2048
    ds_read_b128 v[124:127], v180 offset:4096
    ds_read_b128 v[128:131], v180 offset:6144
    ds_read_b128 v[132:135], v182 offset:0
    ds_read_b64_tr_b16 v[88:89], v9 offset:160
    ds_read_b64_tr_b16 v[90:91], v9 offset:400
    ds_read_b64_tr_b16 v[92:93], v10 offset:0
    ds_read_b64_tr_b16 v[94:95], v10 offset:240
    ds_read_b64_tr_b16 v[96:97], v9 offset:0
    ds_read_b64_tr_b16 v[98:99], v9 offset:240
    s_waitcnt lgkmcnt(7)
    v_mfma_f32_16x16x32_bf16 v[32:35], v[84:87], v[116:119], 0
    s_add_u32 m0, s7, 137216
    s_mov_b32 s67, 442368
    ds_read_b128 v[136:139], v181 offset:0
    v_mfma_f32_16x16x32_bf16 v[36:39], v[84:87], v[120:123], 0
    ds_read_b64_tr_b16 v[100:101], v9 offset:8272
    v_mfma_f32_16x16x32_bf16 v[40:43], v[84:87], v[124:127], 0
    ds_read_b64_tr_b16 v[102:103], v9 offset:8512
    v_mfma_f32_16x16x32_bf16 v[44:47], v[84:87], v[128:131], 0
    ds_read_b128 v[140:143], v181 offset:2048
    s_waitcnt lgkmcnt(8)
    v_mfma_f32_16x16x32_bf16 v[48:51], v[116:119], v[88:91], 0
    v_mfma_f32_16x16x32_bf16 v[52:55], v[120:123], v[88:91], 0
    ds_read_b128 v[144:147], v181 offset:4096
    v_mfma_f32_16x16x32_bf16 v[56:59], v[124:127], v[88:91], 0
    ds_read_b128 v[148:151], v181 offset:6144
    v_mfma_f32_16x16x32_bf16 v[60:63], v[128:131], v[88:91], 0
    ds_read_b128 v[152:155], v183 offset:0
    s_waitcnt lgkmcnt(9)
    v_mfma_f32_16x16x32_bf16 v[80:83], v[92:95], v[132:135], 0
    buffer_load_dwordx4 v7, s[32:35], s67 offen offset:0 lds
    v_mfma_f32_16x16x32_bf16 v[64:67], v[92:95], v[116:119], 0
    ds_read_b64_tr_b16 v[104:105], v9 offset:8352
    v_mfma_f32_16x16x32_bf16 v[68:71], v[92:95], v[120:123], 0
    ds_read_b64_tr_b16 v[106:107], v9 offset:8592
    v_mfma_f32_16x16x32_bf16 v[72:75], v[92:95], v[124:127], 0
    ds_read_b64_tr_b16 v[108:109], v10 offset:8192
    s_waitcnt lgkmcnt(10)
    v_mfma_f32_16x16x32_bf16 v[76:79], v[92:95], v[128:131], 0
    v_mfma_f32_16x16x32_bf16 v[16:19], v[96:99], v[116:119], 0
    ds_read_b64_tr_b16 v[110:111], v10 offset:8432
    v_mfma_f32_16x16x32_bf16 v[20:23], v[96:99], v[120:123], 0
    ds_read_b64_tr_b16 v[112:113], v9 offset:8192
    v_mfma_f32_16x16x32_bf16 v[24:27], v[96:99], v[124:127], 0
    ds_read_b64_tr_b16 v[114:115], v9 offset:8432
    v_mfma_f32_16x16x32_bf16 v[28:31], v[96:99], v[128:131], 0
    s_waitcnt vmcnt(2) lgkmcnt(6)
    s_barrier
    v_mfma_f32_16x16x32_bf16 v[32:35], v[100:103], v[136:139], v[32:35]
    s_add_u32 m0, s7, 145408
    s_mov_b32 s67, 552960
    ds_read_b128 v[116:119], v180 offset:34816
    v_mfma_f32_16x16x32_bf16 v[36:39], v[100:103], v[140:143], v[36:39]
    ds_read_b64_tr_b16 v[84:85], v9 offset:16464
    v_mfma_f32_16x16x32_bf16 v[40:43], v[100:103], v[144:147], v[40:43]
    ds_read_b64_tr_b16 v[86:87], v9 offset:16704
    v_mfma_f32_16x16x32_bf16 v[44:47], v[100:103], v[148:151], v[44:47]
    ds_read_b128 v[120:123], v180 offset:36864
    s_waitcnt lgkmcnt(8)
    v_mfma_f32_16x16x32_bf16 v[48:51], v[136:139], v[104:107], v[48:51]
    v_mfma_f32_16x16x32_bf16 v[52:55], v[140:143], v[104:107], v[52:55]
    ds_read_b128 v[124:127], v180 offset:38912
    v_mfma_f32_16x16x32_bf16 v[56:59], v[144:147], v[104:107], v[56:59]
    ds_read_b128 v[128:131], v180 offset:40960
    v_mfma_f32_16x16x32_bf16 v[60:63], v[148:151], v[104:107], v[60:63]
    ds_read_b128 v[132:135], v182 offset:34816
    s_waitcnt lgkmcnt(9)
    v_mfma_f32_16x16x32_bf16 v[80:83], v[108:111], v[152:155], v[80:83]
    buffer_load_dwordx4 v7, s[32:35], s67 offen offset:0 lds
    v_mfma_f32_16x16x32_bf16 v[64:67], v[108:111], v[136:139], v[64:67]
    ds_read_b64_tr_b16 v[88:89], v9 offset:16544
    v_mfma_f32_16x16x32_bf16 v[68:71], v[108:111], v[140:143], v[68:71]
    ds_read_b64_tr_b16 v[90:91], v9 offset:16784
    v_mfma_f32_16x16x32_bf16 v[72:75], v[108:111], v[144:147], v[72:75]
    ds_read_b64_tr_b16 v[92:93], v10 offset:16384
    s_waitcnt lgkmcnt(10)
    v_mfma_f32_16x16x32_bf16 v[76:79], v[108:111], v[148:151], v[76:79]
    v_mfma_f32_16x16x32_bf16 v[16:19], v[112:115], v[136:139], v[16:19]
    ds_read_b64_tr_b16 v[94:95], v10 offset:16624
    v_mfma_f32_16x16x32_bf16 v[20:23], v[112:115], v[140:143], v[20:23]
    ds_read_b64_tr_b16 v[96:97], v9 offset:16384
    v_mfma_f32_16x16x32_bf16 v[24:27], v[112:115], v[144:147], v[24:27]
    ds_read_b64_tr_b16 v[98:99], v9 offset:16624
    v_mfma_f32_16x16x32_bf16 v[28:31], v[112:115], v[148:151], v[28:31]
    s_waitcnt lgkmcnt(7)
    v_mfma_f32_16x16x32_bf16 v[32:35], v[84:87], v[116:119], v[32:35]
    s_add_u32 m0, s7, 153600
    s_mov_b32 s67, 663552
    ds_read_b128 v[136:139], v181 offset:34816
    v_mfma_f32_16x16x32_bf16 v[36:39], v[84:87], v[120:123], v[36:39]
    ds_read_b64_tr_b16 v[100:101], v9 offset:24656
    v_mfma_f32_16x16x32_bf16 v[40:43], v[84:87], v[124:127], v[40:43]
    ds_read_b64_tr_b16 v[102:103], v9 offset:24896
    v_mfma_f32_16x16x32_bf16 v[44:47], v[84:87], v[128:131], v[44:47]
    ds_read_b128 v[140:143], v181 offset:36864
    s_waitcnt lgkmcnt(8)
    v_mfma_f32_16x16x32_bf16 v[48:51], v[116:119], v[88:91], v[48:51]
    buffer_load_dwordx4 v7, s[32:35], s67 offen offset:0 lds
    v_mfma_f32_16x16x32_bf16 v[52:55], v[120:123], v[88:91], v[52:55]
    ds_read_b128 v[144:147], v181 offset:38912
    v_mfma_f32_16x16x32_bf16 v[56:59], v[124:127], v[88:91], v[56:59]
    ds_read_b128 v[148:151], v181 offset:40960
    v_mfma_f32_16x16x32_bf16 v[60:63], v[128:131], v[88:91], v[60:63]
    ds_read_b128 v[152:155], v183 offset:34816
    s_waitcnt lgkmcnt(9)
    v_mfma_f32_16x16x32_bf16 v[80:83], v[92:95], v[132:135], v[80:83]
    s_add_u32 m0, s7, 104448
    s_mov_b32 s67, 774144
    v_mfma_f32_16x16x32_bf16 v[64:67], v[92:95], v[116:119], v[64:67]
    ds_read_b64_tr_b16 v[104:105], v9 offset:24736
    v_mfma_f32_16x16x32_bf16 v[68:71], v[92:95], v[120:123], v[68:71]
    ds_read_b64_tr_b16 v[106:107], v9 offset:24976
    v_mfma_f32_16x16x32_bf16 v[72:75], v[92:95], v[124:127], v[72:75]
    ds_read_b64_tr_b16 v[108:109], v10 offset:24576
    s_waitcnt lgkmcnt(10)
    v_mfma_f32_16x16x32_bf16 v[76:79], v[92:95], v[128:131], v[76:79]
    buffer_load_dwordx4 v7, s[32:35], s67 offen offset:0 lds
    v_mfma_f32_16x16x32_bf16 v[16:19], v[96:99], v[116:119], v[16:19]
    ds_read_b64_tr_b16 v[110:111], v10 offset:24816
    v_mfma_f32_16x16x32_bf16 v[20:23], v[96:99], v[120:123], v[20:23]
    ds_read_b64_tr_b16 v[112:113], v9 offset:24576
    v_mfma_f32_16x16x32_bf16 v[24:27], v[96:99], v[124:127], v[24:27]
    ds_read_b64_tr_b16 v[114:115], v9 offset:24816
    v_mfma_f32_16x16x32_bf16 v[28:31], v[96:99], v[128:131], v[28:31]
    s_waitcnt vmcnt(2) lgkmcnt(6)
    s_barrier
    v_readfirstlane_b32 s58, v200
    s_nop 0
    s_add_u32 s59, s58, s57
    s_add_u32 s59, s59, 1
    s_cmp_lg_u32 s56, 0
    s_cbranch_scc1 L_noreg_6
    v_mov_b32 v200, s59
    s_mov_b64 exec, 1
    buffer_store_dword v200, v201, s[44:47], s23 offen sc1
    s_mov_b64 exec, -1
L_noreg_6:
    v_mfma_f32_16x16x32_bf16 v[32:35], v[100:103], v[136:139], v[32:35]
    s_add_u32 m0, s7, 112640
    s_mov_b32 s67, 884736
    ds_read_b128 v[116:119], v184 offset:0
    v_mfma_f32_16x16x32_bf16 v[36:39], v[100:103], v[140:143], v[36:39]
    ds_read_b64_tr_b16 v[84:85], v9 offset:32848
    v_mfma_f32_16x16x32_bf16 v[40:43], v[100:103], v[144:147], v[40:43]
    ds_read_b64_tr_b16 v[86:87], v9 offset:33088
    v_mfma_f32_16x16x32_bf16 v[44:47], v[100:103], v[148:151], v[44:47]
    ds_read_b128 v[120:123], v184 offset:2048
    s_waitcnt lgkmcnt(8)
    v_mfma_f32_16x16x32_bf16 v[48:51], v[136:139], v[104:107], v[48:51]
    v_mfma_f32_16x16x32_bf16 v[52:55], v[140:143], v[104:107], v[52:55]
    ds_read_b128 v[124:127], v184 offset:4096
    v_mfma_f32_16x16x32_bf16 v[56:59], v[144:147], v[104:107], v[56:59]
    ds_read_b128 v[128:131], v184 offset:6144
    v_mfma_f32_16x16x32_bf16 v[60:63], v[148:151], v[104:107], v[60:63]
    ds_read_b128 v[132:135], v186 offset:0
    s_waitcnt lgkmcnt(9)
    v_mfma_f32_16x16x32_bf16 v[80:83], v[108:111], v[152:155], v[80:83]
    buffer_load_dwordx4 v7, s[32:35], s67 offen offset:0 lds
    v_mfma_f32_16x16x32_bf16 v[64:67], v[108:111], v[136:139], v[64:67]
    ds_read_b64_tr_b16 v[88:89], v9 offset:32928
    v_mfma_f32_16x16x32_bf16 v[68:71], v[108:111], v[140:143], v[68:71]
    ds_read_b64_tr_b16 v[90:91], v9 offset:33168
    v_mfma_f32_16x16x32_bf16 v[72:75], v[108:111], v[144:147], v[72:75]
    ds_read_b64_tr_b16 v[92:93], v10 offset:32768
    s_waitcnt lgkmcnt(10)
    v_mfma_f32_16x16x32_bf16 v[76:79], v[108:111], v[148:151], v[76:79]
    v_mfma_f32_16x16x32_bf16 v[16:19], v[112:115], v[136:139], v[16:19]
    ds_read_b64_tr_b16 v[94:95], v10 offset:33008
    v_mfma_f32_16x16x32_bf16 v[20:23], v[112:115], v[140:143], v[20:23]
    ds_read_b64_tr_b16 v[96:97], v9 offset:32768
    v_mfma_f32_16x16x32_bf16 v[24:27], v[112:115], v[144:147], v[24:27]
    ds_read_b64_tr_b16 v[98:99], v9 offset:33008
    v_mfma_f32_16x16x32_bf16 v[28:31], v[112:115], v[148:151], v[28:31]
    s_waitcnt lgkmcnt(7)
    v_mfma_f32_16x16x32_bf16 v[32:35], v[84:87], v[116:119], v[32:35]
    s_add_u32 m0, s7, 120832
    s_mov_b32 s67, 995328
    ds_read_b128 v[136:139], v185 offset:0
    v_mfma_f32_16x16x32_bf16 v[36:39], v[84:87], v[120:123], v[36:39]
    ds_read_b64_tr_b16 v[100:101], v9 offset:41040
    v_mfma_f32_16x16x32_bf16 v[40:43], v[84:87], v[124:127], v[40:43]
    ds_read_b64_tr_b16 v[102:103], v9 offset:41280
    v_mfma_f32_16x16x32_bf16 v[44:47], v[84:87], v[128:131], v[44:47]
    ds_read_b128 v[140:143], v185 offset:2048
    s_waitcnt lgkmcnt(8)
    v_mfma_f32_16x16x32_bf16 v[48:51], v[116:119], v[88:91], v[48:51]
    v_mfma_f32_16x16x32_bf16 v[52:55], v[120:123], v[88:91], v[52:55]
    ds_read_b128 v[144:147], v185 offset:4096
    v_mfma_f32_16x16x32_bf16 v[56:59], v[124:127], v[88:91], v[56:59]
    ds_read_b128 v[148:151], v185 offset:6144
    v_mfma_f32_16x16x32_bf16 v[60:63], v[128:131], v[88:91], v[60:63]
    ds_read_b128 v[152:155], v187 offset:0
    s_waitcnt lgkmcnt(9)
    v_mfma_f32_16x16x32_bf16 v[80:83], v[92:95], v[132:135], v[80:83]
    buffer_load_dwordx4 v7, s[32:35], s67 offen offset:0 lds
    v_mfma_f32_16x16x32_bf16 v[64:67], v[92:95], v[116:119], v[64:67]
    ds_read_b64_tr_b16 v[104:105], v9 offset:41120
    v_mfma_f32_16x16x32_bf16 v[68:71], v[92:95], v[120:123], v[68:71]
    ds_read_b64_tr_b16 v[106:107], v9 offset:41360
    v_mfma_f32_16x16x32_bf16 v[72:75], v[92:95], v[124:127], v[72:75]
    ds_read_b64_tr_b16 v[108:109], v10 offset:40960
    s_waitcnt lgkmcnt(10)
    v_mfma_f32_16x16x32_bf16 v[76:79], v[92:95], v[128:131], v[76:79]
    v_mfma_f32_16x16x32_bf16 v[16:19], v[96:99], v[116:119], v[16:19]
    ds_read_b64_tr_b16 v[110:111], v10 offset:41200
    v_mfma_f32_16x16x32_bf16 v[20:23], v[96:99], v[120:123], v[20:23]
    ds_read_b64_tr_b16 v[112:113], v9 offset:40960
    v_mfma_f32_16x16x32_bf16 v[24:27], v[96:99], v[124:127], v[24:27]
    ds_read_b64_tr_b16 v[114:115], v9 offset:41200
    v_mfma_f32_16x16x32_bf16 v[28:31], v[96:99], v[128:131], v[28:31]
    s_waitcnt vmcnt(2) lgkmcnt(6)
    s_barrier
    v_mfma_f32_16x16x32_bf16 v[32:35], v[100:103], v[136:139], v[32:35]
    s_add_u32 m0, s7, 129024
    s_mov_b32 s67, 1105920
    ds_read_b128 v[116:119], v180 offset:0
    v_mfma_f32_16x16x32_bf16 v[36:39], v[100:103], v[140:143], v[36:39]
    ds_read_b64_tr_b16 v[84:85], v9 offset:49232
    v_mfma_f32_16x16x32_bf16 v[40:43], v[100:103], v[144:147], v[40:43]
    ds_read_b64_tr_b16 v[86:87], v9 offset:49472
    v_mfma_f32_16x16x32_bf16 v[44:47], v[100:103], v[148:151], v[44:47]
    ds_read_b128 v[120:123], v180 offset:2048
    s_waitcnt lgkmcnt(8)
    v_mfma_f32_16x16x32_bf16 v[48:51], v[136:139], v[104:107], v[48:51]
    v_mfma_f32_16x16x32_bf16 v[52:55], v[140:143], v[104:107], v[52:55]
    ds_read_b128 v[124:127], v180 offset:4096
    v_mfma_f32_16x16x32_bf16 v[56:59], v[144:147], v[104:107], v[56:59]
    ds_read_b128 v[128:131], v180 offset:6144
    v_mfma_f32_16x16x32_bf16 v[60:63], v[148:151], v[104:107], v[60:63]
    ds_read_b128 v[132:135], v182 offset:0
    s_waitcnt lgkmcnt(9)
    v_mfma_f32_16x16x32_bf16 v[80:83], v[108:111], v[152:155], v[80:83]
    buffer_load_dwordx4 v7, s[32:35], s67 offen offset:0 lds
    v_mfma_f32_16x16x32_bf16 v[64:67], v[108:111], v[136:139], v[64:67]
    ds_read_b64_tr_b16 v[88:89], v9 offset:49312
    v_mfma_f32_16x16x32_bf16 v[68:71], v[108:111], v[140:143], v[68:71]
    ds_read_b64_tr_b16 v[90:91], v9 offset:49552
    v_mfma_f32_16x16x32_bf16 v[72:75], v[108:111], v[144:147], v[72:75]
    ds_read_b64_tr_b16 v[92:93], v10 offset:49152
    s_waitcnt lgkmcnt(10)
    v_mfma_f32_16x16x32_bf16 v[76:79], v[108:111], v[148:151], v[76:79]
    v_mfma_f32_16x16x32_bf16 v[16:19], v[112:115], v[136:139], v[16:19]
    ds_read_b64_tr_b16 v[94:95], v10 offset:49392
    v_mfma_f32_16x16x32_bf16 v[20:23], v[112:115], v[140:143], v[20:23]
    ds_read_b64_tr_b16 v[96:97], v9 offset:49152
    v_mfma_f32_16x16x32_bf16 v[24:27], v[112:115], v[144:147], v[24:27]
    ds_read_b64_tr_b16 v[98:99], v9 offset:49392
    v_mfma_f32_16x16x32_bf16 v[28:31], v[112:115], v[148:151], v[28:31]
    s_waitcnt lgkmcnt(7)
    v_mfma_f32_16x16x32_bf16 v[32:35], v[84:87], v[116:119], v[32:35]
    s_add_u32 m0, s7, 137216
    s_mov_b32 s67, 1216512
    ds_read_b128 v[136:139], v181 offset:0
    v_mfma_f32_16x16x32_bf16 v[36:39], v[84:87], v[120:123], v[36:39]
    ds_read_b64_tr_b16 v[100:101], v9 offset:80
    v_mfma_f32_16x16x32_bf16 v[40:43], v[84:87], v[124:127], v[40:43]
    ds_read_b64_tr_b16 v[102:103], v9 offset:320
    v_mfma_f32_16x16x32_bf16 v[44:47], v[84:87], v[128:131], v[44:47]
    ds_read_b128 v[140:143], v181 offset:2048
    s_waitcnt lgkmcnt(8)
    v_mfma_f32_16x16x32_bf16 v[48:51], v[116:119], v[88:91], v[48:51]
    v_mfma_f32_16x16x32_bf16 v[52:55], v[120:123], v[88:91], v[52:55]
    ds_read_b128 v[144:147], v181 offset:4096
    v_mfma_f32_16x16x32_bf16 v[56:59], v[124:127], v[88:91], v[56:59]
    ds_read_b128 v[148:151], v181 offset:6144
    v_mfma_f32_16x16x32_bf16 v[60:63], v[128:131], v[88:91], v[60:63]
    ds_read_b128 v[152:155], v183 offset:0
    s_waitcnt lgkmcnt(9)
    v_mfma_f32_16x16x32_bf16 v[80:83], v[92:95], v[132:135], v[80:83]
    buffer_load_dwordx4 v7, s[32:35], s67 offen offset:0 lds
    v_mfma_f32_16x16x32_bf16 v[64:67], v[92:95], v[116:119], v[64:67]
    ds_read_b64_tr_b16 v[104:105], v9 offset:160
    v_mfma_f32_16x16x32_bf16 v[68:71], v[92:95], v[120:123], v[68:71]
    ds_read_b64_tr_b16 v[106:107], v9 offset:400
    v_mfma_f32_16x16x32_bf16 v[72:75], v[92:95], v[124:127], v[72:75]
    ds_read_b64_tr_b16 v[108:109], v10 offset:0
    s_waitcnt lgkmcnt(10)
    v_mfma_f32_16x16x32_bf16 v[76:79], v[92:95], v[128:131], v[76:79]
    v_mfma_f32_16x16x32_bf16 v[16:19], v[96:99], v[116:119], v[16:19]
    ds_read_b64_tr_b16 v[110:111], v10 offset:240
    v_mfma_f32_16x16x32_bf16 v[20:23], v[96:99], v[120:123], v[20:23]
    ds_read_b64_tr_b16 v[112:113], v9 offset:0
    v_mfma_f32_16x16x32_bf16 v[24:27], v[96:99], v[124:127], v[24:27]
    ds_read_b64_tr_b16 v[114:115], v9 offset:240
    v_mfma_f32_16x16x32_bf16 v[28:31], v[96:99], v[128:131], v[28:31]
    s_waitcnt vmcnt(2) lgkmcnt(6)
    s_barrier
    v_mfma_f32_16x16x32_bf16 v[32:35], v[100:103], v[136:139], v[32:35]
    s_add_u32 m0, s7, 145408
    s_mov_b32 s67, 1327104
    ds_read_b128 v[116:119], v180 offset:34816
    v_mfma_f32_16x16x32_bf16 v[36:39], v[100:103], v[140:143], v[36:39]
    ds_read_b64_tr_b16 v[84:85], v9 offset:8272
    v_mfma_f32_16x16x32_bf16 v[40:43], v[100:103], v[144:147], v[40:43]
    ds_read_b64_tr_b16 v[86:87], v9 offset:8512
    v_mfma_f32_16x16x32_bf16 v[44:47], v[100:103], v[148:151], v[44:47]
    ds_read_b128 v[120:123], v180 offset:36864
    s_waitcnt lgkmcnt(8)
    v_mfma_f32_16x16x32_bf16 v[48:51], v[136:139], v[104:107], v[48:51]
    v_mfma_f32_16x16x32_bf16 v[52:55], v[140:143], v[104:107], v[52:55]
    ds_read_b128 v[124:127], v180 offset:38912
    v_mfma_f32_16x16x32_bf16 v[56:59], v[144:147], v[104:107], v[56:59]
    ds_read_b128 v[128:131], v180 offset:40960
    v_mfma_f32_16x16x32_bf16 v[60:63], v[148:151], v[104:107], v[60:63]
    ds_read_b128 v[132:135], v182 offset:34816
    s_waitcnt lgkmcnt(9)
    v_mfma_f32_16x16x32_bf16 v[80:83], v[108:111], v[152:155], v[80:83]
    buffer_load_dwordx4 v7, s[32:35], s67 offen offset:0 lds
    v_mfma_f32_16x16x32_bf16 v[64:67], v[108:111], v[136:139], v[64:67]
    ds_read_b64_tr_b16 v[88:89], v9 offset:8352
    v_mfma_f32_16x16x32_bf16 v[68:71], v[108:111], v[140:143], v[68:71]
    ds_read_b64_tr_b16 v[90:91], v9 offset:8592
    v_mfma_f32_16x16x32_bf16 v[72:75], v[108:111], v[144:147], v[72:75]
    ds_read_b64_tr_b16 v[92:93], v10 offset:8192
    s_waitcnt lgkmcnt(10)
    v_mfma_f32_16x16x32_bf16 v[76:79], v[108:111], v[148:151], v[76:79]
    v_mfma_f32_16x16x32_bf16 v[16:19], v[112:115], v[136:139], v[16:19]
    ds_read_b64_tr_b16 v[94:95], v10 offset:8432
    v_mfma_f32_16x16x32_bf16 v[20:23], v[112:115], v[140:143], v[20:23]
    ds_read_b64_tr_b16 v[96:97], v9 offset:8192
    v_mfma_f32_16x16x32_bf16 v[24:27], v[112:115], v[144:147], v[24:27]
    ds_read_b64_tr_b16 v[98:99], v9 offset:8432
    v_mfma_f32_16x16x32_bf16 v[28:31], v[112:115], v[148:151], v[28:31]
    s_waitcnt lgkmcnt(7)
    v_mfma_f32_16x16x32_bf16 v[32:35], v[84:87], v[116:119], v[32:35]
    s_add_u32 m0, s7, 153600
    s_mov_b32 s67, 1437696
    ds_read_b128 v[136:139], v181 offset:34816
    v_mfma_f32_16x16x32_bf16 v[36:39], v[84:87], v[120:123], v[36:39]
    ds_read_b64_tr_b16 v[100:101], v9 offset:16464
    v_mfma_f32_16x16x32_bf16 v[40:43], v[84:87], v[124:127], v[40:43]
    ds_read_b64_tr_b16 v[102:103], v9 offset:16704
    v_mfma_f32_16x16x32_bf16 v[44:47], v[84:87], v[128:131], v[44:47]
    ds_read_b128 v[140:143], v181 offset:36864
    s_waitcnt lgkmcnt(8)
    v_mfma_f32_16x16x32_bf16 v[48:51], v[116:119], v[88:91], v[48:51]
    v_mfma_f32_16x16x32_bf16 v[52:55], v[120:123], v[88:91], v[52:55]
    ds_read_b128 v[144:147], v181 offset:38912
    v_mfma_f32_16x16x32_bf16 v[56:59], v[124:127], v[88:91], v[56:59]
    ds_read_b128 v[148:151], v181 offset:40960
    v_mfma_f32_16x16x32_bf16 v[60:63], v[128:131], v[88:91], v[60:63]
    ds_read_b128 v[152:155], v183 offset:34816
    s_waitcnt lgkmcnt(9)
    v_mfma_f32_16x16x32_bf16 v[80:83], v[92:95], v[132:135], v[80:83]
    buffer_load_dwordx4 v7, s[32:35], s67 offen offset:0 lds
    v_mfma_f32_16x16x32_bf16 v[64:67], v[92:95], v[116:119], v[64:67]
    ds_read_b64_tr_b16 v[104:105], v9 offset:16544
    v_mfma_f32_16x16x32_bf16 v[68:71], v[92:95], v[120:123], v[68:71]
    ds_read_b64_tr_b16 v[106:107], v9 offset:16784
    v_mfma_f32_16x16x32_bf16 v[72:75], v[92:95], v[124:127], v[72:75]
    ds_read_b64_tr_b16 v[108:109], v10 offset:16384
    s_waitcnt lgkmcnt(10)
    v_mfma_f32_16x16x32_bf16 v[76:79], v[92:95], v[128:131], v[76:79]
    v_mfma_f32_16x16x32_bf16 v[16:19], v[96:99], v[116:119], v[16:19]
    ds_read_b64_tr_b16 v[110:111], v10 offset:16624
    v_mfma_f32_16x16x32_bf16 v[20:23], v[96:99], v[120:123], v[20:23]
    ds_read_b64_tr_b16 v[112:113], v9 offset:16384
    v_mfma_f32_16x16x32_bf16 v[24:27], v[96:99], v[124:127], v[24:27]
    ds_read_b64_tr_b16 v[114:115], v9 offset:16624
    v_mfma_f32_16x16x32_bf16 v[28:31], v[96:99], v[128:131], v[28:31]
    s_waitcnt vmcnt(2) lgkmcnt(6)
    s_barrier
    v_mfma_f32_16x16x32_bf16 v[32:35], v[100:103], v[136:139], v[32:35]
    s_add_u32 m0, s7, 104448
    s_mov_b32 s67, 1548288
    ds_read_b128 v[116:119], v184 offset:0
    v_mfma_f32_16x16x32_bf16 v[36:39], v[100:103], v[140:143], v[36:39]
    ds_read_b64_tr_b16 v[84:85], v9 offset:24656
    v_mfma_f32_16x16x32_bf16 v[40:43], v[100:103], v[144:147], v[40:43]
    ds_read_b64_tr_b16 v[86:87], v9 offset:24896
    v_mfma_f32_16x16x32_bf16 v[44:47], v[100:103], v[148:151], v[44:47]
    ds_read_b128 v[120:123], v184 offset:2048
    s_waitcnt lgkmcnt(8)
    v_mfma_f32_16x16x32_bf16 v[48:51], v[136:139], v[104:107], v[48:51]
    v_mfma_f32_16x16x32_bf16 v[52:55], v[140:143], v[104:107], v[52:55]
    ds_read_b128 v[124:127], v184 offset:4096
    v_mfma_f32_16x16x32_bf16 v[56:59], v[144:147], v[104:107], v[56:59]
    ds_read_b128 v[128:131], v184 offset:6144
    v_mfma_f32_16x16x32_bf16 v[60:63], v[148:151], v[104:107], v[60:63]
    ds_read_b128 v[132:135], v186 offset:0
    s_waitcnt lgkmcnt(9)
    v_mfma_f32_16x16x32_bf16 v[80:83], v[108:111], v[152:155], v[80:83]
    buffer_load_dwordx4 v7, s[32:35], s67 offen offset:0 lds
    v_mfma_f32_16x16x32_bf16 v[64:67], v[108:111], v[136:139], v[64:67]
    ds_read_b64_tr_b16 v[88:89], v9 offset:24736
    v_mfma_f32_16x16x32_bf16 v[68:71], v[108:111], v[140:143], v[68:71]
    ds_read_b64_tr_b16 v[90:91], v9 offset:24976
    v_mfma_f32_16x16x32_bf16 v[72:75], v[108:111], v[144:147], v[72:75]
    ds_read_b64_tr_b16 v[92:93], v10 offset:24576
    s_waitcnt lgkmcnt(10)
    v_mfma_f32_16x16x32_bf16 v[76:79], v[108:111], v[148:151], v[76:79]
    v_mfma_f32_16x16x32_bf16 v[16:19], v[112:115], v[136:139], v[16:19]
    ds_read_b64_tr_b16 v[94:95], v10 offset:24816
    v_mfma_f32_16x16x32_bf16 v[20:23], v[112:115], v[140:143], v[20:23]
    ds_read_b64_tr_b16 v[96:97], v9 offset:24576
    v_mfma_f32_16x16x32_bf16 v[24:27], v[112:115], v[144:147], v[24:27]
    ds_read_b64_tr_b16 v[98:99], v9 offset:24816
    v_mfma_f32_16x16x32_bf16 v[28:31], v[112:115], v[148:151], v[28:31]
    s_waitcnt lgkmcnt(7)
    v_mfma_f32_16x16x32_bf16 v[32:35], v[84:87], v[116:119], v[32:35]
    s_add_u32 m0, s7, 112640
    s_mov_b32 s67, 1658880
    ds_read_b128 v[136:139], v185 offset:0
    v_mfma_f32_16x16x32_bf16 v[36:39], v[84:87], v[120:123], v[36:39]
    ds_read_b64_tr_b16 v[100:101], v9 offset:32848
    v_mfma_f32_16x16x32_bf16 v[40:43], v[84:87], v[124:127], v[40:43]
    ds_read_b64_tr_b16 v[102:103], v9 offset:33088
    v_mfma_f32_16x16x32_bf16 v[44:47], v[84:87], v[128:131], v[44:47]
    ds_read_b128 v[140:143], v185 offset:2048
    s_waitcnt lgkmcnt(8)
    v_mfma_f32_16x16x32_bf16 v[48:51], v[116:119], v[88:91], v[48:51]
    v_mfma_f32_16x16x32_bf16 v[52:55], v[120:123], v[88:91], v[52:55]
    ds_read_b128 v[144:147], v185 offset:4096
    v_mfma_f32_16x16x32_bf16 v[56:59], v[124:127], v[88:91], v[56:59]
    ds_read_b128 v[148:151], v185 offset:6144
    v_mfma_f32_16x16x32_bf16 v[60:63], v[128:131], v[88:91], v[60:63]
    ds_read_b128 v[152:155], v187 offset:0
    s_waitcnt lgkmcnt(9)
    v_mfma_f32_16x16x32_bf16 v[80:83], v[92:95], v[132:135], v[80:83]
    buffer_load_dwordx4 v7, s[32:35], s67 offen offset:0 lds
    v_mfma_f32_16x16x32_bf16 v[64:67], v[92:95], v[116:119], v[64:67]
    ds_read_b64_tr_b16 v[104:105], v9 offset:32928
    v_mfma_f32_16x16x32_bf16 v[68:71], v[92:95], v[120:123], v[68:71]
    ds_read_b64_tr_b16 v[106:107], v9 offset:33168
    v_mfma_f32_16x16x32_bf16 v[72:75], v[92:95], v[124:127], v[72:75]
    ds_read_b64_tr_b16 v[108:109], v10 offset:32768
    s_waitcnt lgkmcnt(10)
    v_mfma_f32_16x16x32_bf16 v[76:79], v[92:95], v[128:131], v[76:79]
    v_mfma_f32_16x16x32_bf16 v[16:19], v[96:99], v[116:119], v[16:19]
    ds_read_b64_tr_b16 v[110:111], v10 offset:33008
    v_mfma_f32_16x16x32_bf16 v[20:23], v[96:99], v[120:123], v[20:23]
    ds_read_b64_tr_b16 v[112:113], v9 offset:32768
    v_mfma_f32_16x16x32_bf16 v[24:27], v[96:99], v[124:127], v[24:27]
    ds_read_b64_tr_b16 v[114:115], v9 offset:33008
    v_mfma_f32_16x16x32_bf16 v[28:31], v[96:99], v[128:131], v[28:31]
    s_waitcnt vmcnt(2) lgkmcnt(6)
    s_barrier
    v_mfma_f32_16x16x32_bf16 v[32:35], v[100:103], v[136:139], v[32:35]
    s_add_u32 m0, s7, 120832
    s_mov_b32 s67, 1769472
    ds_read_b128 v[116:119], v180 offset:0
    v_mfma_f32_16x16x32_bf16 v[36:39], v[100:103], v[140:143], v[36:39]
    ds_read_b64_tr_b16 v[84:85], v9 offset:41040
    v_mfma_f32_16x16x32_bf16 v[40:43], v[100:103], v[144:147], v[40:43]
    ds_read_b64_tr_b16 v[86:87], v9 offset:41280
    v_mfma_f32_16x16x32_bf16 v[44:47], v[100:103], v[148:151], v[44:47]
    ds_read_b128 v[120:123], v180 offset:2048
    s_waitcnt lgkmcnt(8)
    v_mfma_f32_16x16x32_bf16 v[48:51], v[136:139], v[104:107], v[48:51]
    v_mfma_f32_16x16x32_bf16 v[52:55], v[140:143], v[104:107], v[52:55]
    ds_read_b128 v[124:127], v180 offset:4096
    v_mfma_f32_16x16x32_bf16 v[56:59], v[144:147], v[104:107], v[56:59]
    ds_read_b128 v[128:131], v180 offset:6144
    v_mfma_f32_16x16x32_bf16 v[60:63], v[148:151], v[104:107], v[60:63]
    ds_read_b128 v[132:135], v182 offset:0
    s_waitcnt lgkmcnt(9)
    v_mfma_f32_16x16x32_bf16 v[80:83], v[108:111], v[152:155], v[80:83]
    buffer_load_dwordx4 v7, s[32:35], s67 offen offset:0 lds
    v_mfma_f32_16x16x32_bf16 v[64:67], v[108:111], v[136:139], v[64:67]
    ds_read_b64_tr_b16 v[88:89], v9 offset:41120
    v_mfma_f32_16x16x32_bf16 v[68:71], v[108:111], v[140:143], v[68:71]
    ds_read_b64_tr_b16 v[90:91], v9 offset:41360
    v_mfma_f32_16x16x32_bf16 v[72:75], v[108:111], v[144:147], v[72:75]
    ds_read_b64_tr_b16 v[92:93], v10 offset:40960
    s_waitcnt lgkmcnt(10)
    v_mfma_f32_16x16x32_bf16 v[76:79], v[108:111], v[148:151], v[76:79]
    v_mfma_f32_16x16x32_bf16 v[16:19], v[112:115], v[136:139], v[16:19]
    ds_read_b64_tr_b16 v[94:95], v10 offset:41200
    v_mfma_f32_16x16x32_bf16 v[20:23], v[112:115], v[140:143], v[20:23]
    ds_read_b64_tr_b16 v[96:97], v9 offset:40960
    v_mfma_f32_16x16x32_bf16 v[24:27], v[112:115], v[144:147], v[24:27]
    ds_read_b64_tr_b16 v[98:99], v9 offset:41200
    v_mfma_f32_16x16x32_bf16 v[28:31], v[112:115], v[148:151], v[28:31]
    s_waitcnt lgkmcnt(7)
    v_mfma_f32_16x16x32_bf16 v[32:35], v[84:87], v[116:119], v[32:35]
    s_add_u32 m0, s7, 129024
    s_mov_b32 s67, 1880064
    ds_read_b128 v[136:139], v181 offset:0
    v_mfma_f32_16x16x32_bf16 v[36:39], v[84:87], v[120:123], v[36:39]
    ds_read_b64_tr_b16 v[100:101], v9 offset:49232
    v_mfma_f32_16x16x32_bf16 v[40:43], v[84:87], v[124:127], v[40:43]
    ds_read_b64_tr_b16 v[102:103], v9 offset:49472
    v_mfma_f32_16x16x32_bf16 v[44:47], v[84:87], v[128:131], v[44:47]
    ds_read_b128 v[140:143], v181 offset:2048
    s_waitcnt lgkmcnt(8)
    v_mfma_f32_16x16x32_bf16 v[48:51], v[116:119], v[88:91], v[48:51]
    v_mfma_f32_16x16x32_bf16 v[52:55], v[120:123], v[88:91], v[52:55]
    ds_read_b128 v[144:147], v181 offset:4096
    v_mfma_f32_16x16x32_bf16 v[56:59], v[124:127], v[88:91], v[56:59]
    ds_read_b128 v[148:151], v181 offset:6144
    v_mfma_f32_16x16x32_bf16 v[60:63], v[128:131], v[88:91], v[60:63]
    ds_read_b128 v[152:155], v183 offset:0
    s_waitcnt lgkmcnt(9)
    v_mfma_f32_16x16x32_bf16 v[80:83], v[92:95], v[132:135], v[80:83]
    buffer_load_dwordx4 v7, s[32:35], s67 offen offset:0 lds
    v_mfma_f32_16x16x32_bf16 v[64:67], v[92:95], v[116:119], v[64:67]
    ds_read_b64_tr_b16 v[104:105], v9 offset:49312
    v_mfma_f32_16x16x32_bf16 v[68:71], v[92:95], v[120:123], v[68:71]
    ds_read_b64_tr_b16 v[106:107], v9 offset:49552
    v_mfma_f32_16x16x32_bf16 v[72:75], v[92:95], v[124:127], v[72:75]
    ds_read_b64_tr_b16 v[108:109], v10 offset:49152
    s_waitcnt lgkmcnt(10)
    v_mfma_f32_16x16x32_bf16 v[76:79], v[92:95], v[128:131], v[76:79]
    v_mfma_f32_16x16x32_bf16 v[16:19], v[96:99], v[116:119], v[16:19]
    ds_read_b64_tr_b16 v[110:111], v10 offset:49392
    v_mfma_f32_16x16x32_bf16 v[20:23], v[96:99], v[120:123], v[20:23]
    ds_read_b64_tr_b16 v[112:113], v9 offset:49152
    v_mfma_f32_16x16x32_bf16 v[24:27], v[96:99], v[124:127], v[24:27]
    ds_read_b64_tr_b16 v[114:115], v9 offset:49392
    v_mfma_f32_16x16x32_bf16 v[28:31], v[96:99], v[128:131], v[28:31]
    s_waitcnt vmcnt(2) lgkmcnt(6)
    s_barrier
    v_mfma_f32_16x16x32_bf16 v[32:35], v[100:103], v[136:139], v[32:35]
    ds_read_b128 v[116:119], v180 offset:34816
    v_mfma_f32_16x16x32_bf16 v[36:39], v[100:103], v[140:143], v[36:39]
    ds_read_b64_tr_b16 v[84:85], v9 offset:80
    v_mfma_f32_16x16x32_bf16 v[40:43], v[100:103], v[144:147], v[40:43]
    ds_read_b64_tr_b16 v[86:87], v9 offset:320
    v_mfma_f32_16x16x32_bf16 v[44:47], v[100:103], v[148:151], v[44:47]
    ds_read_b128 v[120:123], v180 offset:36864
    s_waitcnt lgkmcnt(8)
    v_mfma_f32_16x16x32_bf16 v[48:51], v[136:139], v[104:107], v[48:51]
    v_mfma_f32_16x16x32_bf16 v[52:55], v[140:143], v[104:107], v[52:55]
    ds_read_b128 v[124:127], v180 offset:38912
    v_mfma_f32_16x16x32_bf16 v[56:59], v[144:147], v[104:107], v[56:59]
    ds_read_b128 v[128:131], v180 offset:40960
    v_mfma_f32_16x16x32_bf16 v[60:63], v[148:151], v[104:107], v[60:63]
    ds_read_b128 v[132:135], v182 offset:34816
    s_waitcnt lgkmcnt(9)
    v_mfma_f32_16x16x32_bf16 v[80:83], v[108:111], v[152:155], v[80:83]
    v_mfma_f32_16x16x32_bf16 v[64:67], v[108:111], v[136:139], v[64:67]
    ds_read_b64_tr_b16 v[88:89], v9 offset:160
    v_mfma_f32_16x16x32_bf16 v[68:71], v[108:111], v[140:143], v[68:71]
    ds_read_b64_tr_b16 v[90:91], v9 offset:400
    v_mfma_f32_16x16x32_bf16 v[72:75], v[108:111], v[144:147], v[72:75]
    ds_read_b64_tr_b16 v[92:93], v10 offset:0
    s_waitcnt lgkmcnt(10)
    v_mfma_f32_16x16x32_bf16 v[76:79], v[108:111], v[148:151], v[76:79]
    v_mfma_f32_16x16x32_bf16 v[16:19], v[112:115], v[136:139], v[16:19]
    ds_read_b64_tr_b16 v[94:95], v10 offset:240
    v_mfma_f32_16x16x32_bf16 v[20:23], v[112:115], v[140:143], v[20:23]
    ds_read_b64_tr_b16 v[96:97], v9 offset:0
    v_mfma_f32_16x16x32_bf16 v[24:27], v[112:115], v[144:147], v[24:27]
    ds_read_b64_tr_b16 v[98:99], v9 offset:240
    v_mfma_f32_16x16x32_bf16 v[28:31], v[112:115], v[148:151], v[28:31]
    s_waitcnt lgkmcnt(7)
    v_mfma_f32_16x16x32_bf16 v[32:35], v[84:87], v[116:119], v[32:35]
    ds_read_b128 v[136:139], v181 offset:34816
    v_mfma_f32_16x16x32_bf16 v[36:39], v[84:87], v[120:123], v[36:39]
    ds_read_b64_tr_b16 v[100:101], v9 offset:8272
    v_mfma_f32_16x16x32_bf16 v[40:43], v[84:87], v[124:127], v[40:43]
    ds_read_b64_tr_b16 v[102:103], v9 offset:8512
    v_mfma_f32_16x16x32_bf16 v[44:47], v[84:87], v[128:131], v[44:47]
    ds_read_b128 v[140:143], v181 offset:36864
    s_waitcnt lgkmcnt(8)
    v_mfma_f32_16x16x32_bf16 v[48:51], v[116:119], v[88:91], v[48:51]
    v_mfma_f32_16x16x32_bf16 v[52:55], v[120:123], v[88:91], v[52:55]
    ds_read_b128 v[144:147], v181 offset:38912
    v_mfma_f32_16x16x32_bf16 v[56:59], v[124:127], v[88:91], v[56:59]
    ds_read_b128 v[148:151], v181 offset:40960
    v_mfma_f32_16x16x32_bf16 v[60:63], v[128:131], v[88:91], v[60:63]
    ds_read_b128 v[152:155], v183 offset:34816
    s_waitcnt lgkmcnt(9)
    v_mfma_f32_16x16x32_bf16 v[80:83], v[92:95], v[132:135], v[80:83]
    v_mfma_f32_16x16x32_bf16 v[64:67], v[92:95], v[116:119], v[64:67]
    ds_read_b64_tr_b16 v[104:105], v9 offset:8352
    v_mfma_f32_16x16x32_bf16 v[68:71], v[92:95], v[120:123], v[68:71]
    ds_read_b64_tr_b16 v[106:107], v9 offset:8592
    v_mfma_f32_16x16x32_bf16 v[72:75], v[92:95], v[124:127], v[72:75]
    ds_read_b64_tr_b16 v[108:109], v10 offset:8192
    s_waitcnt lgkmcnt(10)
    v_mfma_f32_16x16x32_bf16 v[76:79], v[92:95], v[128:131], v[76:79]
    v_mfma_f32_16x16x32_bf16 v[16:19], v[96:99], v[116:119], v[16:19]
    ds_read_b64_tr_b16 v[110:111], v10 offset:8432
    v_mfma_f32_16x16x32_bf16 v[20:23], v[96:99], v[120:123], v[20:23]
    ds_read_b64_tr_b16 v[112:113], v9 offset:8192
    v_mfma_f32_16x16x32_bf16 v[24:27], v[96:99], v[124:127], v[24:27]
    ds_read_b64_tr_b16 v[114:115], v9 offset:8432
    v_mfma_f32_16x16x32_bf16 v[28:31], v[96:99], v[128:131], v[28:31]
    s_waitcnt vmcnt(0) lgkmcnt(6)
    s_barrier
    v_mfma_f32_16x16x32_bf16 v[32:35], v[100:103], v[136:139], v[32:35]
    ds_read_b128 v[116:119], v184 offset:0
    v_mfma_f32_16x16x32_bf16 v[36:39], v[100:103], v[140:143], v[36:39]
    ds_read_b64_tr_b16 v[84:85], v9 offset:16464
    v_mfma_f32_16x16x32_bf16 v[40:43], v[100:103], v[144:147], v[40:43]
    ds_read_b64_tr_b16 v[86:87], v9 offset:16704
    v_mfma_f32_16x16x32_bf16 v[44:47], v[100:103], v[148:151], v[44:47]
    ds_read_b128 v[120:123], v184 offset:2048
    s_waitcnt lgkmcnt(8)
    v_mfma_f32_16x16x32_bf16 v[48:51], v[136:139], v[104:107], v[48:51]
    v_mfma_f32_16x16x32_bf16 v[52:55], v[140:143], v[104:107], v[52:55]
    ds_read_b128 v[124:127], v184 offset:4096
    v_mfma_f32_16x16x32_bf16 v[56:59], v[144:147], v[104:107], v[56:59]
    ds_read_b128 v[128:131], v184 offset:6144
    v_mfma_f32_16x16x32_bf16 v[60:63], v[148:151], v[104:107], v[60:63]
    ds_read_b128 v[132:135], v186 offset:0
    s_waitcnt lgkmcnt(9)
    v_mfma_f32_16x16x32_bf16 v[80:83], v[108:111], v[152:155], v[80:83]
    v_mfma_f32_16x16x32_bf16 v[64:67], v[108:111], v[136:139], v[64:67]
    ds_read_b64_tr_b16 v[88:89], v9 offset:16544
    v_mfma_f32_16x16x32_bf16 v[68:71], v[108:111], v[140:143], v[68:71]
    ds_read_b64_tr_b16 v[90:91], v9 offset:16784
    v_mfma_f32_16x16x32_bf16 v[72:75], v[108:111], v[144:147], v[72:75]
    ds_read_b64_tr_b16 v[92:93], v10 offset:16384
    s_waitcnt lgkmcnt(10)
    v_mfma_f32_16x16x32_bf16 v[76:79], v[108:111], v[148:151], v[76:79]
    v_mfma_f32_16x16x32_bf16 v[16:19], v[112:115], v[136:139], v[16:19]
    ds_read_b64_tr_b16 v[94:95], v10 offset:16624
    v_mfma_f32_16x16x32_bf16 v[20:23], v[112:115], v[140:143], v[20:23]
    ds_read_b64_tr_b16 v[96:97], v9 offset:16384
    v_mfma_f32_16x16x32_bf16 v[24:27], v[112:115], v[144:147], v[24:27]
    ds_read_b64_tr_b16 v[98:99], v9 offset:16624
    v_mfma_f32_16x16x32_bf16 v[28:31], v[112:115], v[148:151], v[28:31]
    s_waitcnt lgkmcnt(7)
    v_mfma_f32_16x16x32_bf16 v[32:35], v[84:87], v[116:119], v[32:35]
    ds_read_b128 v[136:139], v185 offset:0
    v_mfma_f32_16x16x32_bf16 v[36:39], v[84:87], v[120:123], v[36:39]
    ds_read_b64_tr_b16 v[100:101], v9 offset:24656
    v_mfma_f32_16x16x32_bf16 v[40:43], v[84:87], v[124:127], v[40:43]
    ds_read_b64_tr_b16 v[102:103], v9 offset:24896
    v_mfma_f32_16x16x32_bf16 v[44:47], v[84:87], v[128:131], v[44:47]
    ds_read_b128 v[140:143], v185 offset:2048
    s_waitcnt lgkmcnt(8)
    v_mfma_f32_16x16x32_bf16 v[48:51], v[116:119], v[88:91], v[48:51]
    v_mfma_f32_16x16x32_bf16 v[52:55], v[120:123], v[88:91], v[52:55]
    ds_read_b128 v[144:147], v185 offset:4096
    v_mfma_f32_16x16x32_bf16 v[56:59], v[124:127], v[88:91], v[56:59]
    ds_read_b128 v[148:151], v185 offset:6144
    v_mfma_f32_16x16x32_bf16 v[60:63], v[128:131], v[88:91], v[60:63]
    ds_read_b128 v[152:155], v187 offset:0
    s_waitcnt lgkmcnt(9)
    v_mfma_f32_16x16x32_bf16 v[80:83], v[92:95], v[132:135], v[80:83]
    v_mfma_f32_16x16x32_bf16 v[64:67], v[92:95], v[116:119], v[64:67]
    ds_read_b64_tr_b16 v[104:105], v9 offset:24736
    v_mfma_f32_16x16x32_bf16 v[68:71], v[92:95], v[120:123], v[68:71]
    ds_read_b64_tr_b16 v[106:107], v9 offset:24976
    v_mfma_f32_16x16x32_bf16 v[72:75], v[92:95], v[124:127], v[72:75]
    ds_read_b64_tr_b16 v[108:109], v10 offset:24576
    s_waitcnt lgkmcnt(10)
    v_mfma_f32_16x16x32_bf16 v[76:79], v[92:95], v[128:131], v[76:79]
    v_mfma_f32_16x16x32_bf16 v[16:19], v[96:99], v[116:119], v[16:19]
    ds_read_b64_tr_b16 v[110:111], v10 offset:24816
    v_mfma_f32_16x16x32_bf16 v[20:23], v[96:99], v[120:123], v[20:23]
    ds_read_b64_tr_b16 v[112:113], v9 offset:24576
    v_mfma_f32_16x16x32_bf16 v[24:27], v[96:99], v[124:127], v[24:27]
    ds_read_b64_tr_b16 v[114:115], v9 offset:24816
    v_mfma_f32_16x16x32_bf16 v[28:31], v[96:99], v[128:131], v[28:31]
    s_waitcnt lgkmcnt(6)
    s_barrier
    v_mfma_f32_16x16x32_bf16 v[44:47], v[100:103], v[148:151], v[44:47]
    v_mfma_f32_16x16x32_bf16 v[32:35], v[100:103], v[136:139], v[32:35]
    v_mfma_f32_16x16x32_bf16 v[36:39], v[100:103], v[140:143], v[36:39]
    v_mfma_f32_16x16x32_bf16 v[40:43], v[100:103], v[144:147], v[40:43]
    s_waitcnt lgkmcnt(4)
    v_mfma_f32_16x16x32_bf16 v[60:63], v[148:151], v[104:107], v[60:63]
    v_mfma_f32_16x16x32_bf16 v[48:51], v[136:139], v[104:107], v[48:51]
    v_mfma_f32_16x16x32_bf16 v[52:55], v[140:143], v[104:107], v[52:55]
    v_mfma_f32_16x16x32_bf16 v[56:59], v[144:147], v[104:107], v[56:59]
    s_waitcnt lgkmcnt(2)
    v_mfma_f32_16x16x32_bf16 v[80:83], v[108:111], v[152:155], v[80:83]
    v_cvt_pk_bf16_f32 v172, v44, v45
    v_cvt_pk_bf16_f32 v173, v46, v47
    v_mfma_f32_16x16x32_bf16 v[64:67], v[108:111], v[136:139], v[64:67]
    ds_write_b64 v208, v[172:173] offset:2048
    v_cvt_pk_bf16_f32 v160, v32, v33
    v_cvt_pk_bf16_f32 v161, v34, v35
    v_mfma_f32_16x16x32_bf16 v[68:71], v[108:111], v[140:143], v[68:71]
    v_cvt_pk_bf16_f32 v92, v60, v61
    v_cvt_pk_bf16_f32 v93, v62, v63
    v_mfma_f32_16x16x32_bf16 v[72:75], v[108:111], v[144:147], v[72:75]
    ds_write_b64 v208, v[92:93] offset:2560
    v_cvt_pk_bf16_f32 v164, v36, v37
    v_cvt_pk_bf16_f32 v165, v38, v39
    s_waitcnt lgkmcnt(0)
    v_mfma_f32_16x16x32_bf16 v[76:79], v[108:111], v[148:151], v[76:79]
    v_cvt_pk_bf16_f32 v168, v40, v41
    v_cvt_pk_bf16_f32 v169, v42, v43
    v_mfma_f32_16x16x32_bf16 v[16:19], v[112:115], v[136:139], v[16:19]
    v_cvt_pk_bf16_f32 v86, v48, v49
    v_cvt_pk_bf16_f32 v87, v50, v51
    v_mfma_f32_16x16x32_bf16 v[20:23], v[112:115], v[140:143], v[20:23]
    v_cvt_pk_bf16_f32 v88, v52, v53
    v_cvt_pk_bf16_f32 v89, v54, v55
    v_mfma_f32_16x16x32_bf16 v[24:27], v[112:115], v[144:147], v[24:27]
    v_cvt_pk_bf16_f32 v90, v56, v57
    v_cvt_pk_bf16_f32 v91, v58, v59
    v_mfma_f32_16x16x32_bf16 v[28:31], v[112:115], v[148:151], v[28:31]
    v_cvt_pk_bf16_f32 v112, v80, v81
    v_cvt_pk_bf16_f32 v113, v82, v83
    ds_write_b64 v210, v[112:113]
    v_cvt_pk_bf16_f32 v104, v64, v65
    v_cvt_pk_bf16_f32 v105, v66, v67
    ds_write_b64 v209, v[104:105] offset:512
    v_cvt_pk_bf16_f32 v106, v68, v69
    v_cvt_pk_bf16_f32 v107, v70, v71
    ds_write_b64 v209, v[106:107] offset:1024
    v_cvt_pk_bf16_f32 v108, v72, v73
    v_cvt_pk_bf16_f32 v109, v74, v75
    ds_write_b64 v209, v[108:109] offset:1536
    v_cvt_pk_bf16_f32 v110, v76, v77
    v_cvt_pk_bf16_f32 v111, v78, v79
    ds_write_b64 v209, v[110:111] offset:2048
    s_branch L_klj_5
L_kl1_4:
    s_add_u32 m0, s7, 120832
    s_mov_b32 s67, 221184
    buffer_load_dwordx4 v8, s[32:35], s67 offen offset:1024 lds
    s_add_u32 m0, s6, 34816
    s_mov_b32 s68, 128
    buffer_load_dwordx4 v2, s[28:31], s68 offen offset:0 lds
    buffer_load_dwordx4 v3, s[28:31], s68 offen offset:1024 lds
    buffer_load_dwordx4 v4, s[28:31], s68 offen offset:2048 lds
    buffer_load_dwordx4 v5, s[28:31], s68 offen offset:3072 lds
    s_cbranch_vccz L_nh_8
    s_add_u32 m0, s63, 34816
    s_nop 0
    buffer_load_dwordx4 v6, s[28:31], s68 offen lds
L_nh_8:
    s_add_u32 m0, s6, 38912
    s_mov_b32 s68, 36992
    buffer_load_dwordx4 v2, s[28:31], s68 offen offset:0 lds
    buffer_load_dwordx4 v3, s[28:31], s68 offen offset:1024 lds
    buffer_load_dwordx4 v4, s[28:31], s68 offen offset:2048 lds
    buffer_load_dwordx4 v5, s[28:31], s68 offen offset:3072 lds
    s_add_u32 m0, s7, 129024
    s_mov_b32 s67, 331776
    buffer_load_dwordx4 v8, s[32:35], s67 offen offset:1024 lds
    v_mov_b32 v201, 0
    buffer_load_dword v200, v201, s[44:47], s22 offen sc1
    s_waitcnt vmcnt(11)
    s_barrier
    ds_read_b128 v[116:119], v180 offset:0
    ds_read_b64_tr_b16 v[84:85], v9 offset:80
    ds_read_b64_tr_b16 v[86:87], v9 offset:320
    ds_read_b128 v[120:123], v180 offset:2048
    ds_read_b128 v[124:127], v180 offset:4096
    ds_read_b128 v[128:131], v180 offset:6144
    ds_read_b128 v[132:135], v182 offset:0
    ds_read_b64_tr_b16 v[88:89], v9 offset:160
    ds_read_b64_tr_b16 v[90:91], v9 offset:400
    ds_read_b64_tr_b16 v[92:93], v10 offset:0
    ds_read_b64_tr_b16 v[94:95], v10 offset:240
    ds_read_b64_tr_b16 v[96:97], v9 offset:0
    ds_read_b64_tr_b16 v[98:99], v9 offset:240
    s_setprio 1
    s_waitcnt lgkmcnt(7)
    v_mfma_f32_16x16x32_bf16 v[32:35], v[84:87], v[116:119], 0
    s_add_u32 m0, s6, 69632
    s_mov_b32 s68, 256
    ds_read_b128 v[136:139], v181 offset:0
    v_mfma_f32_16x16x32_bf16 v[36:39], v[84:87], v[120:123], 0
    buffer_load_dwordx4 v2, s[28:31], s68 offen offset:0 lds
    ds_read_b64_tr_b16 v[100:101], v9 offset:8272
    v_mfma_f32_16x16x32_bf16 v[40:43], v[84:87], v[124:127], 0
    ds_read_b64_tr_b16 v[102:103], v9 offset:8512
    v_mfma_f32_16x16x32_bf16 v[44:47], v[84:87], v[128:131], 0
    buffer_load_dwordx4 v3, s[28:31], s68 offen offset:1024 lds
    ds_read_b128 v[140:143], v181 offset:2048
    s_waitcnt lgkmcnt(8)
    v_mfma_f32_16x16x32_bf16 v[48:51], v[116:119], v[88:91], 0
    buffer_load_dwordx4 v4, s[28:31], s68 offen offset:2048 lds
    ds_read_b128 v[144:147], v181 offset:4096
    v_mfma_f32_16x16x32_bf16 v[52:55], v[120:123], v[88:91], 0
    ds_read_b128 v[148:151], v181 offset:6144
    v_mfma_f32_16x16x32_bf16 v[56:59], v[124:127], v[88:91], 0
    buffer_load_dwordx4 v5, s[28:31], s68 offen offset:3072 lds
    ds_read_b128 v[152:155], v183 offset:0
    v_mfma_f32_16x16x32_bf16 v[60:63], v[128:131], v[88:91], 0
    ds_read_b64_tr_b16 v[104:105], v9 offset:8352
    s_waitcnt lgkmcnt(8)
    v_mfma_f32_16x16x32_bf16 v[80:83], v[92:95], v[132:135], 0
    s_cbranch_vccz L_nh_7
    s_add_u32 m0, s63, 69632
    s_nop 0
    buffer_load_dwordx4 v6, s[28:31], s68 offen lds
L_nh_7:
    ds_read_b64_tr_b16 v[106:107], v9 offset:8592
    v_mfma_f32_16x16x32_bf16 v[16:19], v[96:99], v[116:119], 0
    s_add_u32 m0, s7, 137216
    s_mov_b32 s67, 442368
    ds_read_b64_tr_b16 v[108:109], v10 offset:8192
    v_mfma_f32_16x16x32_bf16 v[20:23], v[96:99], v[120:123], 0
    ds_read_b64_tr_b16 v[110:111], v10 offset:8432
    v_mfma_f32_16x16x32_bf16 v[24:27], v[96:99], v[124:127], 0
    buffer_load_dwordx4 v8, s[32:35], s67 offen offset:1024 lds
    ds_read_b64_tr_b16 v[112:113], v9 offset:8192
    v_mfma_f32_16x16x32_bf16 v[28:31], v[96:99], v[128:131], 0
    ds_read_b64_tr_b16 v[114:115], v9 offset:8432
    s_waitcnt vmcnt(6) lgkmcnt(6)
    s_barrier
    v_mfma_f32_16x16x32_bf16 v[32:35], v[100:103], v[136:139], v[32:35]
    s_add_u32 m0, s6, 73728
    s_mov_b32 s68, 37120
    ds_read_b128 v[116:119], v180 offset:34816
    v_mfma_f32_16x16x32_bf16 v[36:39], v[100:103], v[140:143], v[36:39]
    buffer_load_dwordx4 v2, s[28:31], s68 offen offset:0 lds
    ds_read_b64_tr_b16 v[84:85], v9 offset:16464
    v_mfma_f32_16x16x32_bf16 v[40:43], v[100:103], v[144:147], v[40:43]
    buffer_load_dwordx4 v3, s[28:31], s68 offen offset:1024 lds
    ds_read_b64_tr_b16 v[86:87], v9 offset:16704
    v_mfma_f32_16x16x32_bf16 v[44:47], v[100:103], v[148:151], v[44:47]
    buffer_load_dwordx4 v4, s[28:31], s68 offen offset:2048 lds
    ds_read_b128 v[120:123], v180 offset:36864
    s_waitcnt lgkmcnt(8)
    v_mfma_f32_16x16x32_bf16 v[48:51], v[136:139], v[104:107], v[48:51]
    buffer_load_dwordx4 v5, s[28:31], s68 offen offset:3072 lds
    ds_read_b128 v[124:127], v180 offset:38912
    v_mfma_f32_16x16x32_bf16 v[52:55], v[140:143], v[104:107], v[52:55]
    s_add_u32 m0, s7, 145408
    s_mov_b32 s67, 552960
    ds_read_b128 v[128:131], v180 offset:40960
    v_mfma_f32_16x16x32_bf16 v[56:59], v[144:147], v[104:107], v[56:59]
    buffer_load_dwordx4 v8, s[32:35], s67 offen offset:1024 lds
    ds_read_b128 v[132:135], v182 offset:34816
    v_mfma_f32_16x16x32_bf16 v[60:63], v[148:151], v[104:107], v[60:63]
    s_add_u32 m0, s6, 0
    s_mov_b32 s68, 384
    ds_read_b64_tr_b16 v[88:89], v9 offset:16544
    s_waitcnt lgkmcnt(8)
    v_mfma_f32_16x16x32_bf16 v[80:83], v[108:111], v[152:155], v[80:83]
    buffer_load_dwordx4 v2, s[28:31], s68 offen offset:0 lds
    ds_read_b64_tr_b16 v[90:91], v9 offset:16784
    v_mfma_f32_16x16x32_bf16 v[16:19], v[112:115], v[136:139], v[16:19]
    buffer_load_dwordx4 v3, s[28:31], s68 offen offset:1024 lds
    ds_read_b64_tr_b16 v[92:93], v10 offset:16384
    v_mfma_f32_16x16x32_bf16 v[20:23], v[112:115], v[140:143], v[20:23]
    buffer_load_dwordx4 v4, s[28:31], s68 offen offset:2048 lds
    ds_read_b64_tr_b16 v[94:95], v10 offset:16624
    v_mfma_f32_16x16x32_bf16 v[24:27], v[112:115], v[144:147], v[24:27]
    buffer_load_dwordx4 v5, s[28:31], s68 offen offset:3072 lds
    ds_read_b64_tr_b16 v[96:97], v9 offset:16384
    v_mfma_f32_16x16x32_bf16 v[28:31], v[112:115], v[148:151], v[28:31]
    s_cbranch_vccz L_nh_9
    s_add_u32 m0, s63, 0
    s_nop 0
    buffer_load_dwordx4 v6, s[28:31], s68 offen lds
L_nh_9:
    ds_read_b64_tr_b16 v[98:99], v9 offset:16624
    s_waitcnt lgkmcnt(7)
    v_mfma_f32_16x16x32_bf16 v[32:35], v[84:87], v[116:119], v[32:35]
    s_add_u32 m0, s7, 153600
    s_mov_b32 s67, 663552
    ds_read_b128 v[136:139], v181 offset:34816
    v_mfma_f32_16x16x32_bf16 v[36:39], v[84:87], v[120:123], v[36:39]
    buffer_load_dwordx4 v8, s[32:35], s67 offen offset:1024 lds
    ds_read_b64_tr_b16 v[100:101], v9 offset:24656
    v_mfma_f32_16x16x32_bf16 v[40:43], v[84:87], v[124:127], v[40:43]
    s_add_u32 m0, s6, 4096
    s_mov_b32 s68, 37248
    ds_read_b64_tr_b16 v[102:103], v9 offset:24896
    v_mfma_f32_16x16x32_bf16 v[44:47], v[84:87], v[128:131], v[44:47]
    ds_read_b128 v[140:143], v181 offset:36864
    s_waitcnt lgkmcnt(8)
    v_mfma_f32_16x16x32_bf16 v[48:51], v[116:119], v[88:91], v[48:51]
    buffer_load_dwordx4 v2, s[28:31], s68 offen offset:0 lds
    ds_read_b128 v[144:147], v181 offset:38912
    v_mfma_f32_16x16x32_bf16 v[52:55], v[120:123], v[88:91], v[52:55]
    buffer_load_dwordx4 v3, s[28:31], s68 offen offset:1024 lds
    ds_read_b128 v[148:151], v181 offset:40960
    v_mfma_f32_16x16x32_bf16 v[56:59], v[124:127], v[88:91], v[56:59]
    ds_read_b128 v[152:155], v183 offset:34816
    v_mfma_f32_16x16x32_bf16 v[60:63], v[128:131], v[88:91], v[60:63]
    buffer_load_dwordx4 v4, s[28:31], s68 offen offset:2048 lds
    ds_read_b64_tr_b16 v[104:105], v9 offset:24736
    s_waitcnt lgkmcnt(8)
    v_mfma_f32_16x16x32_bf16 v[80:83], v[92:95], v[132:135], v[80:83]
    buffer_load_dwordx4 v5, s[28:31], s68 offen offset:3072 lds
    ds_read_b64_tr_b16 v[106:107], v9 offset:24976
    v_mfma_f32_16x16x32_bf16 v[16:19], v[96:99], v[116:119], v[16:19]
    ds_read_b64_tr_b16 v[108:109], v10 offset:24576
    v_mfma_f32_16x16x32_bf16 v[20:23], v[96:99], v[120:123], v[20:23]
    s_add_u32 m0, s7, 104448
    s_mov_b32 s67, 774144
    ds_read_b64_tr_b16 v[110:111], v10 offset:24816
    v_mfma_f32_16x16x32_bf16 v[24:27], v[96:99], v[124:127], v[24:27]
    buffer_load_dwordx4 v8, s[32:35], s67 offen offset:1024 lds
    ds_read_b64_tr_b16 v[112:113], v9 offset:24576
    v_mfma_f32_16x16x32_bf16 v[28:31], v[96:99], v[128:131], v[28:31]
    ds_read_b64_tr_b16 v[114:115], v9 offset:24816
    s_waitcnt vmcnt(10) lgkmcnt(6)
    s_barrier
    v_readfirstlane_b32 s58, v200
    s_nop 0
    s_add_u32 s59, s58, s57
    s_add_u32 s59, s59, 1
    v_mfma_f32_16x16x32_bf16 v[32:35], v[100:103], v[136:139], v[32:35]
    s_add_u32 m0, s6, 34816
    s_mov_b32 s68, 512
    ds_read_b128 v[116:119], v184 offset:0
    v_mfma_f32_16x16x32_bf16 v[36:39], v[100:103], v[140:143], v[36:39]
    buffer_load_dwordx4 v2, s[28:31], s68 offen offset:0 lds
    ds_read_b64_tr_b16 v[84:85], v9 offset:32848
    v_mfma_f32_16x16x32_bf16 v[40:43], v[100:103], v[144:147], v[40:43]
    ds_read_b64_tr_b16 v[86:87], v9 offset:33088
    v_mfma_f32_16x16x32_bf16 v[44:47], v[100:103], v[148:151], v[44:47]
    buffer_load_dwordx4 v3, s[28:31], s68 offen offset:1024 lds
    ds_read_b128 v[120:123], v184 offset:2048
    s_waitcnt lgkmcnt(8)
    v_mfma_f32_16x16x32_bf16 v[48:51], v[136:139], v[104:107], v[48:51]
    buffer_load_dwordx4 v4, s[28:31], s68 offen offset:2048 lds
    ds_read_b128 v[124:127], v184 offset:4096
    v_mfma_f32_16x16x32_bf16 v[52:55], v[140:143], v[104:107], v[52:55]
    ds_read_b128 v[128:131], v184 offset:6144
    v_mfma_f32_16x16x32_bf16 v[56:59], v[144:147], v[104:107], v[56:59]
    buffer_load_dwordx4 v5, s[28:31], s68 offen offset:3072 lds
    ds_read_b128 v[132:135], v186 offset:0
    v_mfma_f32_16x16x32_bf16 v[60:63], v[148:151], v[104:107], v[60:63]
    ds_read_b64_tr_b16 v[88:89], v9 offset:32928
    s_waitcnt lgkmcnt(8)
    v_mfma_f32_16x16x32_bf16 v[80:83], v[108:111], v[152:155], v[80:83]
    s_cbranch_vccz L_nh_10
    s_add_u32 m0, s63, 34816
    s_nop 0
    buffer_load_dwordx4 v6, s[28:31], s68 offen lds
L_nh_10:
    ds_read_b64_tr_b16 v[90:91], v9 offset:33168
    v_mfma_f32_16x16x32_bf16 v[16:19], v[112:115], v[136:139], v[16:19]
    s_add_u32 m0, s7, 112640
    s_mov_b32 s67, 884736
    ds_read_b64_tr_b16 v[92:93], v10 offset:32768
    v_mfma_f32_16x16x32_bf16 v[20:23], v[112:115], v[140:143], v[20:23]
    ds_read_b64_tr_b16 v[94:95], v10 offset:33008
    v_mfma_f32_16x16x32_bf16 v[24:27], v[112:115], v[144:147], v[24:27]
    buffer_load_dwordx4 v8, s[32:35], s67 offen offset:1024 lds
    ds_read_b64_tr_b16 v[96:97], v9 offset:32768
    v_mfma_f32_16x16x32_bf16 v[28:31], v[112:115], v[148:151], v[28:31]
    ds_read_b64_tr_b16 v[98:99], v9 offset:33008
    s_waitcnt lgkmcnt(7)
    v_mfma_f32_16x16x32_bf16 v[32:35], v[84:87], v[116:119], v[32:35]
    s_add_u32 m0, s6, 38912
    s_mov_b32 s68, 37376
    ds_read_b128 v[136:139], v185 offset:0
    v_mfma_f32_16x16x32_bf16 v[36:39], v[84:87], v[120:123], v[36:39]
    buffer_load_dwordx4 v2, s[28:31], s68 offen offset:0 lds
    ds_read_b64_tr_b16 v[100:101], v9 offset:41040
    v_mfma_f32_16x16x32_bf16 v[40:43], v[84:87], v[124:127], v[40:43]
    ds_read_b64_tr_b16 v[102:103], v9 offset:41280
    v_mfma_f32_16x16x32_bf16 v[44:47], v[84:87], v[128:131], v[44:47]
    buffer_load_dwordx4 v3, s[28:31], s68 offen offset:1024 lds
    ds_read_b128 v[140:143], v185 offset:2048
    s_waitcnt lgkmcnt(8)
    v_mfma_f32_16x16x32_bf16 v[48:51], v[116:119], v[88:91], v[48:51]
    ds_read_b128 v[144:147], v185 offset:4096
    v_mfma_f32_16x16x32_bf16 v[52:55], v[120:123], v[88:91], v[52:55]
    buffer_load_dwordx4 v4, s[28:31], s68 offen offset:2048 lds
    ds_read_b128 v[148:151], v185 offset:6144
    v_mfma_f32_16x16x32_bf16 v[56:59], v[124:127], v[88:91], v[56:59]
    ds_read_b128 v[152:155], v187 offset:0
    v_mfma_f32_16x16x32_bf16 v[60:63], v[128:131], v[88:91], v[60:63]
    buffer_load_dwordx4 v5, s[28:31], s68 offen offset:3072 lds
    ds_read_b64_tr_b16 v[104:105], v9 offset:41120
    s_waitcnt lgkmcnt(8)
    v_mfma_f32_16x16x32_bf16 v[80:83], v[92:95], v[132:135], v[80:83]
    ds_read_b64_tr_b16 v[106:107], v9 offset:41360
    v_mfma_f32_16x16x32_bf16 v[16:19], v[96:99], v[116:119], v[16:19]
    s_add_u32 m0, s7, 120832
    s_mov_b32 s67, 995328
    ds_read_b64_tr_b16 v[108:109], v10 offset:40960
    v_mfma_f32_16x16x32_bf16 v[20:23], v[96:99], v[120:123], v[20:23]
    ds_read_b64_tr_b16 v[110:111], v10 offset:41200
    v_mfma_f32_16x16x32_bf16 v[24:27], v[96:99], v[124:127], v[24:27]
    buffer_load_dwordx4 v8, s[32:35], s67 offen offset:1024 lds
    ds_read_b64_tr_b16 v[112:113], v9 offset:40960
    v_mfma_f32_16x16x32_bf16 v[28:31], v[96:99], v[128:131], v[28:31]
    ds_read_b64_tr_b16 v[114:115], v9 offset:41200
    s_waitcnt vmcnt(10) lgkmcnt(6)
    s_barrier
    v_mfma_f32_16x16x32_bf16 v[32:35], v[100:103], v[136:139], v[32:35]
    s_add_u32 m0, s6, 69632
    s_mov_b32 s68, 640
    ds_read_b128 v[116:119], v180 offset:0
    v_mfma_f32_16x16x32_bf16 v[36:39], v[100:103], v[140:143], v[36:39]
    buffer_load_dwordx4 v2, s[28:31], s68 offen offset:0 lds
    ds_read_b64_tr_b16 v[84:85], v9 offset:49232
    v_mfma_f32_16x16x32_bf16 v[40:43], v[100:103], v[144:147], v[40:43]
    ds_read_b64_tr_b16 v[86:87], v9 offset:49472
    v_mfma_f32_16x16x32_bf16 v[44:47], v[100:103], v[148:151], v[44:47]
    buffer_load_dwordx4 v3, s[28:31], s68 offen offset:1024 lds
    ds_read_b128 v[120:123], v180 offset:2048
    s_waitcnt lgkmcnt(8)
    v_mfma_f32_16x16x32_bf16 v[48:51], v[136:139], v[104:107], v[48:51]
    buffer_load_dwordx4 v4, s[28:31], s68 offen offset:2048 lds
    ds_read_b128 v[124:127], v180 offset:4096
    v_mfma_f32_16x16x32_bf16 v[52:55], v[140:143], v[104:107], v[52:55]
    ds_read_b128 v[128:131], v180 offset:6144
    v_mfma_f32_16x16x32_bf16 v[56:59], v[144:147], v[104:107], v[56:59]
    buffer_load_dwordx4 v5, s[28:31], s68 offen offset:3072 lds
    ds_read_b128 v[132:135], v182 offset:0
    v_mfma_f32_16x16x32_bf16 v[60:63], v[148:151], v[104:107], v[60:63]
    ds_read_b64_tr_b16 v[88:89], v9 offset:49312
    s_waitcnt lgkmcnt(8)
    v_mfma_f32_16x16x32_bf16 v[80:83], v[108:111], v[152:155], v[80:83]
    s_cbranch_vccz L_nh_11
    s_add_u32 m0, s63, 69632
    s_nop 0
    buffer_load_dwordx4 v6, s[28:31], s68 offen lds
L_nh_11:
    ds_read_b64_tr_b16 v[90:91], v9 offset:49552
    v_mfma_f32_16x16x32_bf16 v[16:19], v[112:115], v[136:139], v[16:19]
    s_add_u32 m0, s7, 129024
    s_mov_b32 s67, 1105920
    ds_read_b64_tr_b16 v[92:93], v10 offset:49152
    v_mfma_f32_16x16x32_bf16 v[20:23], v[112:115], v[140:143], v[20:23]
    ds_read_b64_tr_b16 v[94:95], v10 offset:49392
    v_mfma_f32_16x16x32_bf16 v[24:27], v[112:115], v[144:147], v[24:27]
    buffer_load_dwordx4 v8, s[32:35], s67 offen offset:1024 lds
    ds_read_b64_tr_b16 v[96:97], v9 offset:49152
    v_mfma_f32_16x16x32_bf16 v[28:31], v[112:115], v[148:151], v[28:31]
    ds_read_b64_tr_b16 v[98:99], v9 offset:49392
    s_waitcnt lgkmcnt(7)
    v_mfma_f32_16x16x32_bf16 v[32:35], v[84:87], v[116:119], v[32:35]
    s_add_u32 m0, s6, 73728
    s_mov_b32 s68, 37504
    ds_read_b128 v[136:139], v181 offset:0
    v_mfma_f32_16x16x32_bf16 v[36:39], v[84:87], v[120:123], v[36:39]
    buffer_load_dwordx4 v2, s[28:31], s68 offen offset:0 lds
    ds_read_b64_tr_b16 v[100:101], v9 offset:80
    v_mfma_f32_16x16x32_bf16 v[40:43], v[84:87], v[124:127], v[40:43]
    ds_read_b64_tr_b16 v[102:103], v9 offset:320
    v_mfma_f32_16x16x32_bf16 v[44:47], v[84:87], v[128:131], v[44:47]
    buffer_load_dwordx4 v3, s[28:31], s68 offen offset:1024 lds
    ds_read_b128 v[140:143], v181 offset:2048
    s_waitcnt lgkmcnt(8)
    v_mfma_f32_16x16x32_bf16 v[48:51], v[116:119], v[88:91], v[48:51]
    ds_read_b128 v[144:147], v181 offset:4096
    v_mfma_f32_16x16x32_bf16 v[52:55], v[120:123], v[88:91], v[52:55]
    buffer_load_dwordx4 v4, s[28:31], s68 offen offset:2048 lds
    ds_read_b128 v[148:151], v181 offset:6144
    v_mfma_f32_16x16x32_bf16 v[56:59], v[124:127], v[88:91], v[56:59]
    ds_read_b128 v[152:155], v183 offset:0
    v_mfma_f32_16x16x32_bf16 v[60:63], v[128:131], v[88:91], v[60:63]
    buffer_load_dwordx4 v5, s[28:31], s68 offen offset:3072 lds
    ds_read_b64_tr_b16 v[104:105], v9 offset:160
    s_waitcnt lgkmcnt(8)
    v_mfma_f32_16x16x32_bf16 v[80:83], v[92:95], v[132:135], v[80:83]
    ds_read_b64_tr_b16 v[106:107], v9 offset:400
    v_mfma_f32_16x16x32_bf16 v[16:19], v[96:99], v[116:119], v[16:19]
    s_add_u32 m0, s7, 137216
    s_mov_b32 s67, 1216512
    ds_read_b64_tr_b16 v[108:109], v10 offset:0
    v_mfma_f32_16x16x32_bf16 v[20:23], v[96:99], v[120:123], v[20:23]
    ds_read_b64_tr_b16 v[110:111], v10 offset:240
    v_mfma_f32_16x16x32_bf16 v[24:27], v[96:99], v[124:127], v[24:27]
    buffer_load_dwordx4 v8, s[32:35], s67 offen offset:1024 lds
    ds_read_b64_tr_b16 v[112:113], v9 offset:0
    v_mfma_f32_16x16x32_bf16 v[28:31], v[96:99], v[128:131], v[28:31]
    ds_read_b64_tr_b16 v[114:115], v9 offset:240
    s_waitcnt vmcnt(10) lgkmcnt(6)
    s_barrier
    v_mfma_f32_16x16x32_bf16 v[32:35], v[100:103], v[136:139], v[32:35]
    s_add_u32 m0, s6, 0
    s_mov_b32 s68, 768
    ds_read_b128 v[116:119], v180 offset:34816
    v_mfma_f32_16x16x32_bf16 v[36:39], v[100:103], v[140:143], v[36:39]
    buffer_load_dwordx4 v2, s[28:31], s68 offen offset:0 lds
    ds_read_b64_tr_b16 v[84:85], v9 offset:8272
    v_mfma_f32_16x16x32_bf16 v[40:43], v[100:103], v[144:147], v[40:43]
    ds_read_b64_tr_b16 v[86:87], v9 offset:8512
    v_mfma_f32_16x16x32_bf16 v[44:47], v[100:103], v[148:151], v[44:47]
    buffer_load_dwordx4 v3, s[28:31], s68 offen offset:1024 lds
    ds_read_b128 v[120:123], v180 offset:36864
    s_waitcnt lgkmcnt(8)
    v_mfma_f32_16x16x32_bf16 v[48:51], v[136:139], v[104:107], v[48:51]
    buffer_load_dwordx4 v4, s[28:31], s68 offen offset:2048 lds
    ds_read_b128 v[124:127], v180 offset:38912
    v_mfma_f32_16x16x32_bf16 v[52:55], v[140:143], v[104:107], v[52:55]
    ds_read_b128 v[128:131], v180 offset:40960
    v_mfma_f32_16x16x32_bf16 v[56:59], v[144:147], v[104:107], v[56:59]
    buffer_load_dwordx4 v5, s[28:31], s68 offen offset:3072 lds
    ds_read_b128 v[132:135], v182 offset:34816
    v_mfma_f32_16x16x32_bf16 v[60:63], v[148:151], v[104:107], v[60:63]
    ds_read_b64_tr_b16 v[88:89], v9 offset:8352
    s_waitcnt lgkmcnt(8)
    v_mfma_f32_16x16x32_bf16 v[80:83], v[108:111], v[152:155], v[80:83]
    s_cbranch_vccz L_nh_12
    s_add_u32 m0, s63, 0
    s_nop 0
    buffer_load_dwordx4 v6, s[28:31], s68 offen lds
L_nh_12:
    ds_read_b64_tr_b16 v[90:91], v9 offset:8592
    v_mfma_f32_16x16x32_bf16 v[16:19], v[112:115], v[136:139], v[16:19]
    s_add_u32 m0, s7, 145408
    s_mov_b32 s67, 1327104
    ds_read_b64_tr_b16 v[92:93], v10 offset:8192
    v_mfma_f32_16x16x32_bf16 v[20:23], v[112:115], v[140:143], v[20:23]
    ds_read_b64_tr_b16 v[94:95], v10 offset:8432
    v_mfma_f32_16x16x32_bf16 v[24:27], v[112:115], v[144:147], v[24:27]
    buffer_load_dwordx4 v8, s[32:35], s67 offen offset:1024 lds
    ds_read_b64_tr_b16 v[96:97], v9 offset:8192
    v_mfma_f32_16x16x32_bf16 v[28:31], v[112:115], v[148:151], v[28:31]
    ds_read_b64_tr_b16 v[98:99], v9 offset:8432
    s_waitcnt lgkmcnt(7)
    v_mfma_f32_16x16x32_bf16 v[32:35], v[84:87], v[116:119], v[32:35]
    s_add_u32 m0, s6, 4096
    s_mov_b32 s68, 37632
    ds_read_b128 v[136:139], v181 offset:34816
    v_mfma_f32_16x16x32_bf16 v[36:39], v[84:87], v[120:123], v[36:39]
    buffer_load_dwordx4 v2, s[28:31], s68 offen offset:0 lds
    ds_read_b64_tr_b16 v[100:101], v9 offset:16464
    v_mfma_f32_16x16x32_bf16 v[40:43], v[84:87], v[124:127], v[40:43]
    ds_read_b64_tr_b16 v[102:103], v9 offset:16704
    v_mfma_f32_16x16x32_bf16 v[44:47], v[84:87], v[128:131], v[44:47]
    buffer_load_dwordx4 v3, s[28:31], s68 offen offset:1024 lds
    ds_read_b128 v[140:143], v181 offset:36864
    s_waitcnt lgkmcnt(8)
    v_mfma_f32_16x16x32_bf16 v[48:51], v[116:119], v[88:91], v[48:51]
    ds_read_b128 v[144:147], v181 offset:38912
    v_mfma_f32_16x16x32_bf16 v[52:55], v[120:123], v[88:91], v[52:55]
    buffer_load_dwordx4 v4, s[28:31], s68 offen offset:2048 lds
    ds_read_b128 v[148:151], v181 offset:40960
    v_mfma_f32_16x16x32_bf16 v[56:59], v[124:127], v[88:91], v[56:59]
    ds_read_b128 v[152:155], v183 offset:34816
    v_mfma_f32_16x16x32_bf16 v[60:63], v[128:131], v[88:91], v[60:63]
    buffer_load_dwordx4 v5, s[28:31], s68 offen offset:3072 lds
    ds_read_b64_tr_b16 v[104:105], v9 offset:16544
    s_waitcnt lgkmcnt(8)
    v_mfma_f32_16x16x32_bf16 v[80:83], v[92:95], v[132:135], v[80:83]
    ds_read_b64_tr_b16 v[106:107], v9 offset:16784
    v_mfma_f32_16x16x32_bf16 v[16:19], v[96:99], v[116:119], v[16:19]
    s_add_u32 m0, s7, 153600
    s_mov_b32 s67, 1437696
    ds_read_b64_tr_b16 v[108:109], v10 offset:16384
    v_mfma_f32_16x16x32_bf16 v[20:23], v[96:99], v[120:123], v[20:23]
    ds_read_b64_tr_b16 v[110:111], v10 offset:16624
    v_mfma_f32_16x16x32_bf16 v[24:27], v[96:99], v[124:127], v[24:27]
    buffer_load_dwordx4 v8, s[32:35], s67 offen offset:1024 lds
    ds_read_b64_tr_b16 v[112:113], v9 offset:16384
    v_mfma_f32_16x16x32_bf16 v[28:31], v[96:99], v[128:131], v[28:31]
    ds_read_b64_tr_b16 v[114:115], v9 offset:16624
    s_waitcnt vmcnt(10) lgkmcnt(6)
    s_barrier
    v_mfma_f32_16x16x32_bf16 v[32:35], v[100:103], v[136:139], v[32:35]
    s_add_u32 m0, s6, 34816
    s_mov_b32 s68, 896
    ds_read_b128 v[116:119], v184 offset:0
    v_mfma_f32_16x16x32_bf16 v[36:39], v[100:103], v[140:143], v[36:39]
    buffer_load_dwordx4 v2, s[28:31], s68 offen offset:0 lds
    ds_read_b64_tr_b16 v[84:85], v9 offset:24656
    v_mfma_f32_16x16x32_bf16 v[40:43], v[100:103], v[144:147], v[40:43]
    ds_read_b64_tr_b16 v[86:87], v9 offset:24896
    v_mfma_f32_16x16x32_bf16 v[44:47], v[100:103], v[148:151], v[44:47]
    buffer_load_dwordx4 v3, s[28:31], s68 offen offset:1024 lds
    ds_read_b128 v[120:123], v184 offset:2048
    s_waitcnt lgkmcnt(8)
    v_mfma_f32_16x16x32_bf16 v[48:51], v[136:139], v[104:107], v[48:51]
    buffer_load_dwordx4 v4, s[28:31], s68 offen offset:2048 lds
    ds_read_b128 v[124:127], v184 offset:4096
    v_mfma_f32_16x16x32_bf16 v[52:55], v[140:143], v[104:107], v[52:55]
    ds_read_b128 v[128:131], v184 offset:6144
    v_mfma_f32_16x16x32_bf16 v[56:59], v[144:147], v[104:107], v[56:59]
    buffer_load_dwordx4 v5, s[28:31], s68 offen offset:3072 lds
    ds_read_b128 v[132:135], v186 offset:0
    v_mfma_f32_16x16x32_bf16 v[60:63], v[148:151], v[104:107], v[60:63]
    ds_read_b64_tr_b16 v[88:89], v9 offset:24736
    s_waitcnt lgkmcnt(8)
    v_mfma_f32_16x16x32_bf16 v[80:83], v[108:111], v[152:155], v[80:83]
    s_cbranch_vccz L_nh_13
    s_add_u32 m0, s63, 34816
    s_nop 0
    buffer_load_dwordx4 v6, s[28:31], s68 offen lds
L_nh_13:
    ds_read_b64_tr_b16 v[90:91], v9 offset:24976
    v_mfma_f32_16x16x32_bf16 v[16:19], v[112:115], v[136:139], v[16:19]
    s_add_u32 m0, s7, 104448
    s_mov_b32 s67, 1548288
    ds_read_b64_tr_b16 v[92:93], v10 offset:24576
    v_mfma_f32_16x16x32_bf16 v[20:23], v[112:115], v[140:143], v[20:23]
    ds_read_b64_tr_b16 v[94:95], v10 offset:24816
    v_mfma_f32_16x16x32_bf16 v[24:27], v[112:115], v[144:147], v[24:27]
    buffer_load_dwordx4 v8, s[32:35], s67 offen offset:1024 lds
    ds_read_b64_tr_b16 v[96:97], v9 offset:24576
    v_mfma_f32_16x16x32_bf16 v[28:31], v[112:115], v[148:151], v[28:31]
    ds_read_b64_tr_b16 v[98:99], v9 offset:24816
    s_waitcnt lgkmcnt(7)
    v_mfma_f32_16x16x32_bf16 v[32:35], v[84:87], v[116:119], v[32:35]
    s_add_u32 m0, s6, 38912
    s_mov_b32 s68, 37760
    ds_read_b128 v[136:139], v185 offset:0
    v_mfma_f32_16x16x32_bf16 v[36:39], v[84:87], v[120:123], v[36:39]
    buffer_load_dwordx4 v2, s[28:31], s68 offen offset:0 lds
    ds_read_b64_tr_b16 v[100:101], v9 offset:32848
    v_mfma_f32_16x16x32_bf16 v[40:43], v[84:87], v[124:127], v[40:43]
    ds_read_b64_tr_b16 v[102:103], v9 offset:33088
    v_mfma_f32_16x16x32_bf16 v[44:47], v[84:87], v[128:131], v[44:47]
    buffer_load_dwordx4 v3, s[28:31], s68 offen offset:1024 lds
    ds_read_b128 v[140:143], v185 offset:2048
    s_waitcnt lgkmcnt(8)
    v_mfma_f32_16x16x32_bf16 v[48:51], v[116:119], v[88:91], v[48:51]
    ds_read_b128 v[144:147], v185 offset:4096
    v_mfma_f32_16x16x32_bf16 v[52:55], v[120:123], v[88:91], v[52:55]
    buffer_load_dwordx4 v4, s[28:31], s68 offen offset:2048 lds
    ds_read_b128 v[148:151], v185 offset:6144
    v_mfma_f32_16x16x32_bf16 v[56:59], v[124:127], v[88:91], v[56:59]
    ds_read_b128 v[152:155], v187 offset:0
    v_mfma_f32_16x16x32_bf16 v[60:63], v[128:131], v[88:91], v[60:63]
    buffer_load_dwordx4 v5, s[28:31], s68 offen offset:3072 lds
    ds_read_b64_tr_b16 v[104:105], v9 offset:32928
    s_waitcnt lgkmcnt(8)
    v_mfma_f32_16x16x32_bf16 v[80:83], v[92:95], v[132:135], v[80:83]
    ds_read_b64_tr_b16 v[106:107], v9 offset:33168
    v_mfma_f32_16x16x32_bf16 v[16:19], v[96:99], v[116:119], v[16:19]
    s_add_u32 m0, s7, 112640
    s_mov_b32 s67, 1658880
    ds_read_b64_tr_b16 v[108:109], v10 offset:32768
    v_mfma_f32_16x16x32_bf16 v[20:23], v[96:99], v[120:123], v[20:23]
    ds_read_b64_tr_b16 v[110:111], v10 offset:33008
    v_mfma_f32_16x16x32_bf16 v[24:27], v[96:99], v[124:127], v[24:27]
    buffer_load_dwordx4 v8, s[32:35], s67 offen offset:1024 lds
    ds_read_b64_tr_b16 v[112:113], v9 offset:32768
    v_mfma_f32_16x16x32_bf16 v[28:31], v[96:99], v[128:131], v[28:31]
    ds_read_b64_tr_b16 v[114:115], v9 offset:33008
    s_waitcnt vmcnt(10) lgkmcnt(6)
    s_barrier
    v_mfma_f32_16x16x32_bf16 v[32:35], v[100:103], v[136:139], v[32:35]
    s_add_u32 m0, s6, 69632
    s_mov_b32 s68, 1024
    ds_read_b128 v[116:119], v180 offset:0
    v_mfma_f32_16x16x32_bf16 v[36:39], v[100:103], v[140:143], v[36:39]
    buffer_load_dwordx4 v2, s[28:31], s68 offen offset:0 lds
    ds_read_b64_tr_b16 v[84:85], v9 offset:41040
    v_mfma_f32_16x16x32_bf16 v[40:43], v[100:103], v[144:147], v[40:43]
    ds_read_b64_tr_b16 v[86:87], v9 offset:41280
    v_mfma_f32_16x16x32_bf16 v[44:47], v[100:103], v[148:151], v[44:47]
    buffer_load_dwordx4 v3, s[28:31], s68 offen offset:1024 lds
    ds_read_b128 v[120:123], v180 offset:2048
    s_waitcnt lgkmcnt(8)
    v_mfma_f32_16x16x32_bf16 v[48:51], v[136:139], v[104:107], v[48:51]
    buffer_load_dwordx4 v4, s[28:31], s68 offen offset:2048 lds
    ds_read_b128 v[124:127], v180 offset:4096
    v_mfma_f32_16x16x32_bf16 v[52:55], v[140:143], v[104:107], v[52:55]
    ds_read_b128 v[128:131], v180 offset:6144
    v_mfma_f32_16x16x32_bf16 v[56:59], v[144:147], v[104:107], v[56:59]
    buffer_load_dwordx4 v5, s[28:31], s68 offen offset:3072 lds
    ds_read_b128 v[132:135], v182 offset:0
    v_mfma_f32_16x16x32_bf16 v[60:63], v[148:151], v[104:107], v[60:63]
    ds_read_b64_tr_b16 v[88:89], v9 offset:41120
    s_waitcnt lgkmcnt(8)
    v_mfma_f32_16x16x32_bf16 v[80:83], v[108:111], v[152:155], v[80:83]
    s_cbranch_vccz L_nh_14
    s_add_u32 m0, s63, 69632
    s_nop 0
    buffer_load_dwordx4 v6, s[28:31], s68 offen lds
L_nh_14:
    ds_read_b64_tr_b16 v[90:91], v9 offset:41360
    v_mfma_f32_16x16x32_bf16 v[16:19], v[112:115], v[136:139], v[16:19]
    s_add_u32 m0, s7, 120832
    s_mov_b32 s67, 1769472
    ds_read_b64_tr_b16 v[92:93], v10 offset:40960
    v_mfma_f32_16x16x32_bf16 v[20:23], v[112:115], v[140:143], v[20:23]
    ds_read_b64_tr_b16 v[94:95], v10 offset:41200
    v_mfma_f32_16x16x32_bf16 v[24:27], v[112:115], v[144:147], v[24:27]
    buffer_load_dwordx4 v8, s[32:35], s67 offen offset:1024 lds
    ds_read_b64_tr_b16 v[96:97], v9 offset:40960
    v_mfma_f32_16x16x32_bf16 v[28:31], v[112:115], v[148:151], v[28:31]
    ds_read_b64_tr_b16 v[98:99], v9 offset:41200
    s_waitcnt lgkmcnt(7)
    v_mfma_f32_16x16x32_bf16 v[32:35], v[84:87], v[116:119], v[32:35]
    s_add_u32 m0, s6, 73728
    s_mov_b32 s68, 37888
    ds_read_b128 v[136:139], v181 offset:0
    v_mfma_f32_16x16x32_bf16 v[36:39], v[84:87], v[120:123], v[36:39]
    buffer_load_dwordx4 v2, s[28:31], s68 offen offset:0 lds
    ds_read_b64_tr_b16 v[100:101], v9 offset:49232
    v_mfma_f32_16x16x32_bf16 v[40:43], v[84:87], v[124:127], v[40:43]
    ds_read_b64_tr_b16 v[102:103], v9 offset:49472
    v_mfma_f32_16x16x32_bf16 v[44:47], v[84:87], v[128:131], v[44:47]
    buffer_load_dwordx4 v3, s[28:31], s68 offen offset:1024 lds
    ds_read_b128 v[140:143], v181 offset:2048
    s_waitcnt lgkmcnt(8)
    v_mfma_f32_16x16x32_bf16 v[48:51], v[116:119], v[88:91], v[48:51]
    ds_read_b128 v[144:147], v181 offset:4096
    v_mfma_f32_16x16x32_bf16 v[52:55], v[120:123], v[88:91], v[52:55]
    buffer_load_dwordx4 v4, s[28:31], s68 offen offset:2048 lds
    ds_read_b128 v[148:151], v181 offset:6144
    v_mfma_f32_16x16x32_bf16 v[56:59], v[124:127], v[88:91], v[56:59]
    ds_read_b128 v[152:155], v183 offset:0
    v_mfma_f32_16x16x32_bf16 v[60:63], v[128:131], v[88:91], v[60:63]
    buffer_load_dwordx4 v5, s[28:31], s68 offen offset:3072 lds
    ds_read_b64_tr_b16 v[104:105], v9 offset:49312
    s_waitcnt lgkmcnt(8)
    v_mfma_f32_16x16x32_bf16 v[80:83], v[92:95], v[132:135], v[80:83]
    ds_read_b64_tr_b16 v[106:107], v9 offset:49552
    v_mfma_f32_16x16x32_bf16 v[16:19], v[96:99], v[116:119], v[16:19]
    s_add_u32 m0, s7, 129024
    s_mov_b32 s67, 1880064
    ds_read_b64_tr_b16 v[108:109], v10 offset:49152
    v_mfma_f32_16x16x32_bf16 v[20:23], v[96:99], v[120:123], v[20:23]
    ds_read_b64_tr_b16 v[110:111], v10 offset:49392
    v_mfma_f32_16x16x32_bf16 v[24:27], v[96:99], v[124:127], v[24:27]
    buffer_load_dwordx4 v8, s[32:35], s67 offen offset:1024 lds
    ds_read_b64_tr_b16 v[112:113], v9 offset:49152
    v_mfma_f32_16x16x32_bf16 v[28:31], v[96:99], v[128:131], v[28:31]
    ds_read_b64_tr_b16 v[114:115], v9 offset:49392
    s_waitcnt vmcnt(10) lgkmcnt(6)
    s_barrier
    v_mfma_f32_16x16x32_bf16 v[32:35], v[100:103], v[136:139], v[32:35]
    s_mov_b32 s25, 580608
    s_add_u32 m0, s5, 137216
    ds_read_b128 v[116:119], v180 offset:34816
    v_mfma_f32_16x16x32_bf16 v[36:39], v[100:103], v[140:143], v[36:39]
    buffer_load_dwordx4 v188, s[36:39], s25 offen lds
    ds_read_b64_tr_b16 v[84:85], v9 offset:80
    v_mfma_f32_16x16x32_bf16 v[40:43], v[100:103], v[144:147], v[40:43]
    s_add_u32 m0, m0, 4096
    ds_read_b64_tr_b16 v[86:87], v9 offset:320
    v_mfma_f32_16x16x32_bf16 v[44:47], v[100:103], v[148:151], v[44:47]
    buffer_load_dwordx4 v189, s[36:39], s25 offen lds
    ds_read_b128 v[120:123], v180 offset:36864
    s_waitcnt lgkmcnt(8)
    v_mfma_f32_16x16x32_bf16 v[48:51], v[136:139], v[104:107], v[48:51]
    s_add_u32 m0, s4, 145408
    ds_read_b128 v[124:127], v180 offset:38912
    v_mfma_f32_16x16x32_bf16 v[52:55], v[140:143], v[104:107], v[52:55]
    s_mov_b64 exec, 0xffff
    buffer_load_dwordx4 v190, s[36:39], s25 offen lds
    s_mov_b64 exec, -1
    ds_read_b128 v[128:131], v180 offset:40960
    v_mfma_f32_16x16x32_bf16 v[56:59], v[144:147], v[104:107], v[56:59]
    s_mov_b32 s25, 0
    s_add_u32 m0, s5, 0
    ds_read_b128 v[132:135], v182 offset:34816
    v_mfma_f32_16x16x32_bf16 v[60:63], v[148:151], v[104:107], v[60:63]
    buffer_load_dwordx4 v188, s[36:39], s25 offen lds
    ds_read_b64_tr_b16 v[88:89], v9 offset:160
    s_waitcnt lgkmcnt(8)
    v_mfma_f32_16x16x32_bf16 v[80:83], v[108:111], v[152:155], v[80:83]
    s_add_u32 m0, m0, 4096
    ds_read_b64_tr_b16 v[90:91], v9 offset:400
    v_mfma_f32_16x16x32_bf16 v[16:19], v[112:115], v[136:139], v[16:19]
    buffer_load_dwordx4 v189, s[36:39], s25 offen lds
    ds_read_b64_tr_b16 v[92:93], v10 offset:0
    v_mfma_f32_16x16x32_bf16 v[20:23], v[112:115], v[140:143], v[20:23]
    s_add_u32 m0, s4, 8192
    ds_read_b64_tr_b16 v[94:95], v10 offset:240
    v_mfma_f32_16x16x32_bf16 v[24:27], v[112:115], v[144:147], v[24:27]
    s_mov_b64 exec, 0xffff
    buffer_load_dwordx4 v190, s[36:39], s25 offen lds
    s_mov_b64 exec, -1
    ds_read_b64_tr_b16 v[96:97], v9 offset:0
    v_mfma_f32_16x16x32_bf16 v[28:31], v[112:115], v[148:151], v[28:31]
    ds_read_b64_tr_b16 v[98:99], v9 offset:240
    s_waitcnt lgkmcnt(7)
    v_mfma_f32_16x16x32_bf16 v[32:35], v[84:87], v[116:119], v[32:35]
    s_mov_b32 s25, 82944
    s_add_u32 m0, s5, 9216
    ds_read_b128 v[136:139], v181 offset:34816
    v_mfma_f32_16x16x32_bf16 v[36:39], v[84:87], v[120:123], v[36:39]
    buffer_load_dwordx4 v188, s[36:39], s25 offen lds
    ds_read_b64_tr_b16 v[100:101], v9 offset:8272
    v_mfma_f32_16x16x32_bf16 v[40:43], v[84:87], v[124:127], v[40:43]
    s_add_u32 m0, m0, 4096
    ds_read_b64_tr_b16 v[102:103], v9 offset:8512
    v_mfma_f32_16x16x32_bf16 v[44:47], v[84:87], v[128:131], v[44:47]
    buffer_load_dwordx4 v189, s[36:39], s25 offen lds
    ds_read_b128 v[140:143], v181 offset:36864
    s_waitcnt lgkmcnt(8)
    v_mfma_f32_16x16x32_bf16 v[48:51], v[116:119], v[88:91], v[48:51]
    s_add_u32 m0, s4, 17408
    ds_read_b128 v[144:147], v181 offset:38912
    v_mfma_f32_16x16x32_bf16 v[52:55], v[120:123], v[88:91], v[52:55]
    s_mov_b64 exec, 0xffff
    buffer_load_dwordx4 v190, s[36:39], s25 offen lds
    s_mov_b64 exec, -1
    ds_read_b128 v[148:151], v181 offset:40960
    v_mfma_f32_16x16x32_bf16 v[56:59], v[124:127], v[88:91], v[56:59]
    s_mov_b32 s25, 165888
    s_add_u32 m0, s5, 18432
    ds_read_b128 v[152:155], v183 offset:34816
    v_mfma_f32_16x16x32_bf16 v[60:63], v[128:131], v[88:91], v[60:63]
    buffer_load_dwordx4 v188, s[36:39], s25 offen lds
    ds_read_b64_tr_b16 v[104:105], v9 offset:8352
    s_waitcnt lgkmcnt(8)
    v_mfma_f32_16x16x32_bf16 v[80:83], v[92:95], v[132:135], v[80:83]
    s_add_u32 m0, m0, 4096
    ds_read_b64_tr_b16 v[106:107], v9 offset:8592
    v_mfma_f32_16x16x32_bf16 v[16:19], v[96:99], v[116:119], v[16:19]
    buffer_load_dwordx4 v189, s[36:39], s25 offen lds
    ds_read_b64_tr_b16 v[108:109], v10 offset:8192
    v_mfma_f32_16x16x32_bf16 v[20:23], v[96:99], v[120:123], v[20:23]
    s_add_u32 m0, s4, 26624
    ds_read_b64_tr_b16 v[110:111], v10 offset:8432
    v_mfma_f32_16x16x32_bf16 v[24:27], v[96:99], v[124:127], v[24:27]
    s_mov_b64 exec, 0xffff
    buffer_load_dwordx4 v190, s[36:39], s25 offen lds
    s_mov_b64 exec, -1
    ds_read_b64_tr_b16 v[112:113], v9 offset:8192
    v_mfma_f32_16x16x32_bf16 v[28:31], v[96:99], v[128:131], v[28:31]
    ds_read_b64_tr_b16 v[114:115], v9 offset:8432
    s_waitcnt vmcnt(12) lgkmcnt(6)
    s_barrier
    v_mfma_f32_16x16x32_bf16 v[32:35], v[100:103], v[136:139], v[32:35]
    s_add_u32 m0, s5, 146432
    ds_read_b128 v[116:119], v184 offset:0
    v_mfma_f32_16x16x32_bf16 v[36:39], v[100:103], v[140:143], v[36:39]
    buffer_load_dwordx4 v191, s[36:39], 0 offen lds
    ds_read_b64_tr_b16 v[84:85], v9 offset:16464
    v_mfma_f32_16x16x32_bf16 v[40:43], v[100:103], v[144:147], v[40:43]
    s_add_u32 m0, m0, 4096
    ds_read_b64_tr_b16 v[86:87], v9 offset:16704
    v_mfma_f32_16x16x32_bf16 v[44:47], v[100:103], v[148:151], v[44:47]
    buffer_load_dwordx4 v176, s[36:39], 0 offen lds
    ds_read_b128 v[120:123], v184 offset:2048
    s_waitcnt lgkmcnt(8)
    v_mfma_f32_16x16x32_bf16 v[48:51], v[136:139], v[104:107], v[48:51]
    s_add_u32 m0, s4, 154624
    ds_read_b128 v[124:127], v184 offset:4096
    v_mfma_f32_16x16x32_bf16 v[52:55], v[140:143], v[104:107], v[52:55]
    s_mov_b64 exec, 0xffff
    buffer_load_dwordx4 v177, s[36:39], 0 offen lds
    s_mov_b64 exec, -1
    ds_read_b128 v[128:131], v184 offset:6144
    v_mfma_f32_16x16x32_bf16 v[56:59], v[144:147], v[104:107], v[56:59]
    s_mov_b32 s25, 248832
    s_add_u32 m0, s5, 27648
    ds_read_b128 v[132:135], v186 offset:0
    v_mfma_f32_16x16x32_bf16 v[60:63], v[148:151], v[104:107], v[60:63]
    buffer_load_dwordx4 v188, s[36:39], s25 offen lds
    ds_read_b64_tr_b16 v[88:89], v9 offset:16544
    s_waitcnt lgkmcnt(8)
    v_mfma_f32_16x16x32_bf16 v[80:83], v[108:111], v[152:155], v[80:83]
    s_add_u32 m0, m0, 4096
    ds_read_b64_tr_b16 v[90:91], v9 offset:16784
    v_mfma_f32_16x16x32_bf16 v[16:19], v[112:115], v[136:139], v[16:19]
    buffer_load_dwordx4 v189, s[36:39], s25 offen lds
    ds_read_b64_tr_b16 v[92:93], v10 offset:16384
    v_mfma_f32_16x16x32_bf16 v[20:23], v[112:115], v[140:143], v[20:23]
    s_add_u32 m0, s4, 35840
    ds_read_b64_tr_b16 v[94:95], v10 offset:16624
    v_mfma_f32_16x16x32_bf16 v[24:27], v[112:115], v[144:147], v[24:27]
    s_mov_b64 exec, 0xffff
    buffer_load_dwordx4 v190, s[36:39], s25 offen lds
    s_mov_b64 exec, -1
    ds_read_b64_tr_b16 v[96:97], v9 offset:16384
    v_mfma_f32_16x16x32_bf16 v[28:31], v[112:115], v[148:151], v[28:31]
    ds_read_b64_tr_b16 v[98:99], v9 offset:16624
    s_waitcnt lgkmcnt(7)
    v_mfma_f32_16x16x32_bf16 v[32:35], v[84:87], v[116:119], v[32:35]
    s_mov_b32 s25, 331776
    s_add_u32 m0, s5, 36864
    ds_read_b128 v[136:139], v185 offset:0
    v_mfma_f32_16x16x32_bf16 v[36:39], v[84:87], v[120:123], v[36:39]
    buffer_load_dwordx4 v188, s[36:39], s25 offen lds
    ds_read_b64_tr_b16 v[100:101], v9 offset:24656
    v_mfma_f32_16x16x32_bf16 v[40:43], v[84:87], v[124:127], v[40:43]
    s_add_u32 m0, m0, 4096
    ds_read_b64_tr_b16 v[102:103], v9 offset:24896
    v_mfma_f32_16x16x32_bf16 v[44:47], v[84:87], v[128:131], v[44:47]
    buffer_load_dwordx4 v189, s[36:39], s25 offen lds
    ds_read_b128 v[140:143], v185 offset:2048
    s_waitcnt lgkmcnt(8)
    v_mfma_f32_16x16x32_bf16 v[48:51], v[116:119], v[88:91], v[48:51]
    s_add_u32 m0, s4, 45056
    ds_read_b128 v[144:147], v185 offset:4096
    v_mfma_f32_16x16x32_bf16 v[52:55], v[120:123], v[88:91], v[52:55]
    s_mov_b64 exec, 0xffff
    buffer_load_dwordx4 v190, s[36:39], s25 offen lds
    s_mov_b64 exec, -1
    ds_read_b128 v[148:151], v185 offset:6144
    v_mfma_f32_16x16x32_bf16 v[56:59], v[124:127], v[88:91], v[56:59]
    s_mov_b32 s25, 414720
    s_add_u32 m0, s5, 46080
    ds_read_b128 v[152:155], v187 offset:0
    v_mfma_f32_16x16x32_bf16 v[60:63], v[128:131], v[88:91], v[60:63]
    buffer_load_dwordx4 v188, s[36:39], s25 offen lds
    ds_read_b64_tr_b16 v[104:105], v9 offset:24736
    s_waitcnt lgkmcnt(8)
    v_mfma_f32_16x16x32_bf16 v[80:83], v[92:95], v[132:135], v[80:83]
    s_add_u32 m0, m0, 4096
    ds_read_b64_tr_b16 v[106:107], v9 offset:24976
    v_mfma_f32_16x16x32_bf16 v[16:19], v[96:99], v[116:119], v[16:19]
    buffer_load_dwordx4 v189, s[36:39], s25 offen lds
    ds_read_b64_tr_b16 v[108:109], v10 offset:24576
    v_mfma_f32_16x16x32_bf16 v[20:23], v[96:99], v[120:123], v[20:23]
    s_add_u32 m0, s4, 54272
    ds_read_b64_tr_b16 v[110:111], v10 offset:24816
    v_mfma_f32_16x16x32_bf16 v[24:27], v[96:99], v[124:127], v[24:27]
    s_mov_b64 exec, 0xffff
    buffer_load_dwordx4 v190, s[36:39], s25 offen lds
    s_mov_b64 exec, -1
    ds_read_b64_tr_b16 v[112:113], v9 offset:24576
    v_mfma_f32_16x16x32_bf16 v[28:31], v[96:99], v[128:131], v[28:31]
    ds_read_b64_tr_b16 v[114:115], v9 offset:24816
    s_waitcnt lgkmcnt(6)
    s_barrier
    v_mfma_f32_16x16x32_bf16 v[44:47], v[100:103], v[148:151], v[44:47]
    s_mov_b32 s25, 497664
    s_add_u32 m0, s5, 55296
    v_mfma_f32_16x16x32_bf16 v[32:35], v[100:103], v[136:139], v[32:35]
    v_mfma_f32_16x16x32_bf16 v[36:39], v[100:103], v[140:143], v[36:39]
    buffer_load_dwordx4 v188, s[36:39], s25 offen lds
    v_mfma_f32_16x16x32_bf16 v[40:43], v[100:103], v[144:147], v[40:43]
    s_waitcnt lgkmcnt(4)
    v_mfma_f32_16x16x32_bf16 v[60:63], v[148:151], v[104:107], v[60:63]
    s_add_u32 m0, m0, 4096
    v_mfma_f32_16x16x32_bf16 v[48:51], v[136:139], v[104:107], v[48:51]
    v_mfma_f32_16x16x32_bf16 v[52:55], v[140:143], v[104:107], v[52:55]
    buffer_load_dwordx4 v189, s[36:39], s25 offen lds
    v_mfma_f32_16x16x32_bf16 v[56:59], v[144:147], v[104:107], v[56:59]
    s_waitcnt lgkmcnt(0)
    v_mfma_f32_16x16x32_bf16 v[80:83], v[108:111], v[152:155], v[80:83]
    v_cvt_pk_bf16_f32 v172, v44, v45
    v_cvt_pk_bf16_f32 v173, v46, v47
    s_add_u32 m0, s4, 63488
    v_mfma_f32_16x16x32_bf16 v[16:19], v[112:115], v[136:139], v[16:19]
    ds_write_b64 v208, v[172:173] offset:2048
    v_cvt_pk_bf16_f32 v160, v32, v33
    v_cvt_pk_bf16_f32 v161, v34, v35
    v_mfma_f32_16x16x32_bf16 v[20:23], v[112:115], v[140:143], v[20:23]
    v_cvt_pk_bf16_f32 v92, v60, v61
    v_cvt_pk_bf16_f32 v93, v62, v63
    s_mov_b64 exec, 0xffff
    buffer_load_dwordx4 v190, s[36:39], s25 offen lds
    s_mov_b64 exec, -1
    v_mfma_f32_16x16x32_bf16 v[24:27], v[112:115], v[144:147], v[24:27]
    ds_write_b64 v208, v[92:93] offset:2560
    v_cvt_pk_bf16_f32 v164, v36, v37
    v_cvt_pk_bf16_f32 v165, v38, v39
    v_mfma_f32_16x16x32_bf16 v[28:31], v[112:115], v[148:151], v[28:31]
    v_cvt_pk_bf16_f32 v168, v40, v41
    v_cvt_pk_bf16_f32 v169, v42, v43
    s_setprio 0
    v_cvt_pk_bf16_f32 v112, v80, v81
    v_cvt_pk_bf16_f32 v113, v82, v83
    ds_write_b64 v210, v[112:113]
    v_cvt_pk_bf16_f32 v86, v48, v49
    v_cvt_pk_bf16_f32 v87, v50, v51
    v_cvt_pk_bf16_f32 v88, v52, v53
    v_cvt_pk_bf16_f32 v89, v54, v55
    v_cvt_pk_bf16_f32 v90, v56, v57
    v_cvt_pk_bf16_f32 v91, v58, v59
L_klj_5:
    v_cvt_pk_bf16_f32 v232, v16, v17
    v_cvt_pk_bf16_f32 v233, v18, v19
    v_cvt_pk_bf16_f32 v236, v20, v21
    v_cvt_pk_bf16_f32 v237, v22, v23
    v_cvt_pk_bf16_f32 v240, v24, v25
    v_cvt_pk_bf16_f32 v241, v26, v27
    v_cvt_pk_bf16_f32 v244, v28, v29
    v_cvt_pk_bf16_f32 v245, v30, v31
    s_waitcnt vmcnt(15) lgkmcnt(0)
    s_barrier
    s_mov_b64 exec, 0xffff
    ds_read_b32 v246, v211 offset:2048
    ds_read_b32 v242, v211 offset:1536
    ds_read_b32 v238, v211 offset:1024
    ds_read_b32 v234, v211 offset:512
    s_mov_b64 exec, -1
    ds_read_b32 v174, v211 offset:2176
    ds_read_b32 v170, v211 offset:1664
    ds_read_b32 v166, v211 offset:1152
    ds_read_b32 v162, v211 offset:640
    ds_read_b32 v158, v211 offset:128
    ds_read_b64 v[156:157], v208
    ds_read_b64_tr_b16 v[94:95], v212 offset:256
    ds_read_b64_tr_b16 v[96:97], v212 offset:768
    ds_read_b64_tr_b16 v[98:99], v212 offset:1280
    ds_read_b64_tr_b16 v[100:101], v212 offset:1792
    ds_read_b64_tr_b16 v[102:103], v212 offset:2304
    s_cmp_eq_u32 s66, 0
    s_cbranch_scc1 L_vh_15
    ds_read_b64 v[84:85], v208 offset:512
    s_branch L_vh_16
L_vh_15:
    ds_read_b64_tr_b16 v[84:85], v213
L_vh_16:
    s_waitcnt lgkmcnt(10)
    v_mfma_f32_16x16x32_bf16 v[40:43], v[172:175], v[244:247], 0
    v_mfma_f32_16x16x32_bf16 v[44:47], v[168:171], v[244:247], 0
    s_waitcnt lgkmcnt(9)
    v_mfma_f32_16x16x32_bf16 v[32:35], v[168:171], v[240:243], 0
    v_mfma_f32_16x16x32_bf16 v[36:39], v[164:167], v[240:243], 0
    s_waitcnt lgkmcnt(8)
    v_mfma_f32_16x16x32_bf16 v[24:27], v[164:167], v[236:239], 0
    v_mfma_f32_16x16x32_bf16 v[28:31], v[160:163], v[236:239], 0
    s_waitcnt lgkmcnt(6)
    v_mfma_f32_16x16x32_bf16 v[16:19], v[160:163], v[232:235], 0
    v_mfma_f32_16x16x32_bf16 v[20:23], v[156:159], v[232:235], 0
    s_mov_b64 vcc, s[10:11]
    v_cndmask_b32 v40, v40, v41, vcc
    v_cndmask_b32 v44, v44, v45, vcc
    v_cndmask_b32 v42, v42, v43, vcc
    v_cndmask_b32 v46, v46, v47, vcc
    v_cndmask_b32 v54, v44, v40, s[12:13]
    v_cndmask_b32 v55, v46, v42, s[14:15]
    v_cndmask_b32 v32, v32, v33, vcc
    v_cndmask_b32 v36, v36, v37, vcc
    v_cndmask_b32 v34, v34, v35, vcc
    v_cndmask_b32 v38, v38, v39, vcc
    v_cndmask_b32 v52, v36, v32, s[12:13]
    v_cndmask_b32 v53, v38, v34, s[14:15]
    v_cndmask_b32 v24, v24, v25, vcc
    v_cndmask_b32 v28, v28, v29, vcc
    v_cndmask_b32 v26, v26, v27, vcc
    v_cndmask_b32 v30, v30, v31, vcc
    v_cndmask_b32 v50, v28, v24, s[12:13]
    v_cndmask_b32 v51, v30, v26, s[14:15]
    v_cndmask_b32 v16, v16, v17, vcc
    v_cndmask_b32 v20, v20, v21, vcc
    v_cndmask_b32 v18, v18, v19, vcc
    v_cndmask_b32 v22, v22, v23, vcc
    v_cndmask_b32 v48, v20, v16, s[12:13]
    v_cndmask_b32 v49, v22, v18, s[14:15]
    v_cndmask_b32 v48, v199, v48, s[16:17]
    v_cndmask_b32 v49, v199, v49, s[18:19]
    v_max_f32 v59, v54, v55
    v_max_f32 v58, v52, v53
    v_max_f32 v57, v50, v51
    v_max_f32 v56, v48, v49
    v_permlane32_swap_b32 v58, v59
    s_nop 0
    v_permlane32_swap_b32 v56, v57
    v_max_f32 v58, v58, v59
    v_max_f32 v56, v56, v57
    s_nop 1
    v_permlane16_swap_b32 v56, v58
    v_max_f32 v56, v56, v58
    v_mul_f32 v56, s20, v56
    v_mov_b32 v58, v56
    s_nop 1
    v_permlane16_swap_b32 v56, v58
    v_mov_b32 v57, v56
    v_mov_b32 v59, v58
    s_nop 0
    v_permlane32_swap_b32 v56, v57
    v_permlane32_swap_b32 v58, v59
    v_pk_fma_f32 v[48:49], v[48:49], s[20:21], v[56:57] op_sel:[0,0,0] op_sel_hi:[1,1,0] neg_lo:[0,0,1] neg_hi:[0,0,1]
    v_pk_fma_f32 v[50:51], v[50:51], s[20:21], v[56:57] op_sel:[0,0,1] op_sel_hi:[1,1,1] neg_lo:[0,0,1] neg_hi:[0,0,1]
    v_pk_fma_f32 v[52:53], v[52:53], s[20:21], v[58:59] op_sel:[0,0,0] op_sel_hi:[1,1,0] neg_lo:[0,0,1] neg_hi:[0,0,1]
    v_pk_fma_f32 v[54:55], v[54:55], s[20:21], v[58:59] op_sel:[0,0,1] op_sel_hi:[1,1,1] neg_lo:[0,0,1] neg_hi:[0,0,1]
    v_exp_f32 v48, v48
    v_exp_f32 v49, v49
    v_exp_f32 v50, v50
    v_exp_f32 v51, v51
    v_exp_f32 v52, v52
    v_exp_f32 v53, v53
    v_exp_f32 v54, v54
    v_exp_f32 v55, v55
    s_nop 0
    v_add_f32 v59, v54, v55
    v_add_f32 v58, v52, v53
    v_add_f32 v57, v50, v51
    v_add_f32 v56, v48, v49
    v_permlane32_swap_b32 v58, v59
    s_nop 0
    v_permlane32_swap_b32 v56, v57
    v_add_f32 v58, v58, v59
    v_add_f32 v56, v56, v57
    s_nop 1
    v_permlane16_swap_b32 v56, v58
    v_add_f32 v56, v56, v58
    v_rcp_f32 v56, v56
    s_nop 0
    v_mov_b32 v58, v56
    s_nop 1
    v_permlane16_swap_b32 v56, v58
    v_mov_b32 v57, v56
    v_mov_b32 v59, v58
    s_nop 0
    v_permlane32_swap_b32 v56, v57
    v_permlane32_swap_b32 v58, v59
    v_pk_mul_f32 v[48:49], v[48:49], v[56:57] op_sel:[0,0] op_sel_hi:[1,0]
    v_pk_mul_f32 v[50:51], v[50:51], v[56:57] op_sel:[0,1] op_sel_hi:[1,1]
    v_pk_mul_f32 v[52:53], v[52:53], v[58:59] op_sel:[0,0] op_sel_hi:[1,0]
    v_pk_mul_f32 v[54:55], v[54:55], v[58:59] op_sel:[0,1] op_sel_hi:[1,1]
    v_cvt_pk_bf16_f32 v60, v48, v49
    v_cvt_pk_bf16_f32 v61, v50, v51
    v_cvt_pk_bf16_f32 v62, v52, v53
    v_cvt_pk_bf16_f32 v63, v54, v55
    s_waitcnt lgkmcnt(0)
    v_perm_b32 v64, v60, v60, v192
    v_perm_b32 v65, v60, v60, v193
    v_perm_b32 v66, v60, v60, v194
    v_perm_b32 v67, v60, v60, v195
    v_perm_b32 v68, v61, v61, v192
    v_perm_b32 v69, v61, v61, v193
    v_perm_b32 v70, v61, v61, v194
    v_perm_b32 v71, v61, v61, v195
    v_mfma_f32_16x16x32_bf16 v[16:19], v[84:87], v[64:67], 0
    v_mfma_f32_16x16x32_bf16 v[32:35], v[94:97], v[64:67], 0
    v_perm_b32 v72, v62, v62, v192
    v_perm_b32 v73, v62, v62, v193
    v_perm_b32 v74, v62, v62, v194
    v_perm_b32 v75, v62, v62, v195
    v_mfma_f32_16x16x32_bf16 v[20:23], v[86:89], v[68:71], 0
    v_mfma_f32_16x16x32_bf16 v[36:39], v[96:99], v[68:71], 0
    v_perm_b32 v76, v63, v63, v192
    v_perm_b32 v77, v63, v63, v193
    v_perm_b32 v78, v63, v63, v194
    v_perm_b32 v79, v63, v63, v195
    v_mfma_f32_16x16x32_bf16 v[24:27], v[88:91], v[72:75], 0
    v_mfma_f32_16x16x32_bf16 v[40:43], v[98:101], v[72:75], 0
    v_mfma_f32_16x16x32_bf16 v[28:31], v[90:93], v[76:79], 0
    v_mfma_f32_16x16x32_bf16 v[44:47], v[100:103], v[76:79], 0
    s_mov_b32 s25, 18432
    s_mov_b32 s67, 36864
    s_mov_b32 s68, 55296
    v_cvt_pk_bf16_f32 v140, v16, v17
    v_cvt_pk_bf16_f32 v141, v18, v19
    v_cvt_pk_bf16_f32 v142, v20, v21
    v_cvt_pk_bf16_f32 v143, v22, v23
    v_cvt_pk_bf16_f32 v144, v24, v25
    v_cvt_pk_bf16_f32 v145, v26, v27
    v_cvt_pk_bf16_f32 v146, v28, v29
    v_cvt_pk_bf16_f32 v147, v30, v31
    s_cmp_lg_u32 s69, 0
    s_cbranch_scc1 L_ox_17
    v_cvt_pk_bf16_f32 v148, v32, v33
    v_cvt_pk_bf16_f32 v149, v36, v37
    v_cvt_pk_bf16_f32 v150, v40, v41
    v_cvt_pk_bf16_f32 v151, v44, v45
    s_branch L_ox_18
L_ox_17:
    v_cvt_pk_bf16_f32 v148, v34, v35
    v_cvt_pk_bf16_f32 v149, v38, v39
    v_cvt_pk_bf16_f32 v150, v42, v43
    v_cvt_pk_bf16_f32 v151, v46, v47
L_ox_18:
    s_mov_b32 vcc_lo, 0xffff0000
    s_mov_b32 vcc_hi, 0xffff0000
    v_cndmask_b32 v148, v148, v149, vcc
    v_cndmask_b32 v150, v150, v151, vcc
    s_mov_b32 vcc_lo, 0
    s_mov_b32 vcc_hi, -1
    v_cndmask_b32 v148, v148, v150, vcc
    buffer_store_dwordx2 v[140:141], v214, s[44:47], 0 offen nt
    buffer_store_dwordx2 v[142:143], v214, s[44:47], s25 offen nt
    buffer_store_dwordx2 v[144:145], v214, s[44:47], s67 offen nt
    buffer_store_dwordx2 v[146:147], v214, s[44:47], s68 offen nt
    buffer_store_dword v148, v215, s[44:47], 0 offen nt
    ds_read_b64_tr_b16 v[16:17], v205 offset:0
    ds_read_b64_tr_b16 v[18:19], v205 offset:144
    ds_read_b64_tr_b16 v[20:21], v205 offset:32
    ds_read_b64_tr_b16 v[22:23], v205 offset:176
    ds_read_b64_tr_b16 v[24:25], v205 offset:64
    ds_read_b64_tr_b16 v[26:27], v205 offset:208
    ds_read_b64_tr_b16 v[28:29], v205 offset:96
    ds_read_b64_tr_b16 v[30:31], v205 offset:240
    ds_read_b64_tr_b16 v[32:33], v205 offset:128
    ds_read_b64_tr_b16 v[34:35], v205 offset:272
    ds_read_b64_tr_b16 v[36:37], v205 offset:4608
    ds_read_b64_tr_b16 v[38:39], v205 offset:4752
    ds_read_b64_tr_b16 v[40:41], v205 offset:4640
    ds_read_b64_tr_b16 v[42:43], v205 offset:4784
    ds_read_b64_tr_b16 v[44:45], v205 offset:4672
    ds_read_b64_tr_b16 v[46:47], v205 offset:4816
    ds_read_b64_tr_b16 v[48:49], v205 offset:4704
    ds_read_b64_tr_b16 v[50:51], v205 offset:4848
    ds_read_b64_tr_b16 v[52:53], v205 offset:4736
    ds_read_b64_tr_b16 v[54:55], v205 offset:4880
    v_mov_b32 v226, s59
    s_waitcnt vmcnt(0)
    s_mov_b64 exec, 1
    buffer_store_dword v226, v197, s[44:47], 0 offen
    s_mov_b64 exec, -1
    s_barrier
    buffer_load_dword v228, v198, s[44:47], 0 offen sc1
    ds_read_b64_tr_b16 v[56:57], v205 offset:9216
    ds_read_b64_tr_b16 v[58:59], v205 offset:9360
    ds_read_b64_tr_b16 v[60:61], v205 offset:9248
    ds_read_b64_tr_b16 v[62:63], v205 offset:9392
    ds_read_b64_tr_b16 v[64:65], v205 offset:9280
    ds_read_b64_tr_b16 v[66:67], v205 offset:9424
    ds_read_b64_tr_b16 v[68:69], v205 offset:9312
    ds_read_b64_tr_b16 v[70:71], v205 offset:9456
    ds_read_b64_tr_b16 v[72:73], v205 offset:9344
    ds_read_b64_tr_b16 v[74:75], v205 offset:9488
    ds_read_b64_tr_b16 v[76:77], v205 offset:13824
    ds_read_b64_tr_b16 v[78:79], v205 offset:13968
    ds_read_b64_tr_b16 v[80:81], v205 offset:13856
    ds_read_b64_tr_b16 v[82:83], v205 offset:14000
    ds_read_b64_tr_b16 v[84:85], v205 offset:13888
    ds_read_b64_tr_b16 v[86:87], v205 offset:14032
    ds_read_b64_tr_b16 v[88:89], v205 offset:13920
    ds_read_b64_tr_b16 v[90:91], v205 offset:14064
    ds_read_b64_tr_b16 v[92:93], v205 offset:13952
    ds_read_b64_tr_b16 v[94:95], v205 offset:14096
    ds_read_b64_tr_b16 v[96:97], v205 offset:18432
    ds_read_b64_tr_b16 v[98:99], v205 offset:18576
    ds_read_b64_tr_b16 v[100:101], v205 offset:18464
    ds_read_b64_tr_b16 v[102:103], v205 offset:18608
    ds_read_b64_tr_b16 v[104:105], v205 offset:18496
    ds_read_b64_tr_b16 v[106:107], v205 offset:18640
    ds_read_b64_tr_b16 v[108:109], v205 offset:18528
    ds_read_b64_tr_b16 v[110:111], v205 offset:18672
    ds_read_b64_tr_b16 v[112:113], v205 offset:18560
    ds_read_b64_tr_b16 v[114:115], v205 offset:18704
    ds_read_b64_tr_b16 v[116:117], v205 offset:23040
    ds_read_b64_tr_b16 v[118:119], v205 offset:23184
    ds_read_b64_tr_b16 v[120:121], v205 offset:23072
    ds_read_b64_tr_b16 v[122:123], v205 offset:23216
    ds_read_b64_tr_b16 v[124:125], v205 offset:23104
    ds_read_b64_tr_b16 v[126:127], v205 offset:23248
    ds_read_b64_tr_b16 v[128:129], v205 offset:23136
    ds_read_b64_tr_b16 v[130:131], v205 offset:23280
    ds_read_b64_tr_b16 v[132:133], v205 offset:23168
    ds_read_b64_tr_b16 v[134:135], v205 offset:23312
    s_waitcnt vmcnt(0)
    v_cmp_ne_u32 vcc, s59, v228
    s_cbranch_vccz L_got_19
    s_mov_b32 s63, 6
    buffer_load_dword v226, v198, s[44:47], s60 offen sc1
    s_sleep 3
L_fp_20:
    buffer_load_dword v217, v198, s[44:47], s60 offen sc1
    s_waitcnt vmcnt(1)
    v_cmp_ne_u32 vcc, s59, v226
    s_cbranch_vccz L_got_19
    buffer_load_dword v226, v198, s[44:47], s60 offen sc1
    s_sub_u32 s63, s63, 1
    s_waitcnt vmcnt(1)
    v_cmp_ne_u32 vcc, s59, v217
    s_cbranch_vccz L_got_19
    s_cmp_lg_u32 s63, 0
    s_cbranch_scc1 L_fp_20
    s_waitcnt vmcnt(0)
    s_mov_b32 s63, 524288
L_poll_21:
    buffer_load_dword v226, v198, s[44:47], s60 offen sc1
    s_sub_u32 s63, s63, 1
    s_waitcnt vmcnt(0)
    v_cmp_ne_u32 vcc, s59, v226
    s_cbranch_vccz L_polld_22
    s_and_b32 s61, s63, 7
    s_or_b32 s61, s61, s60
    s_cmp_lg_u32 s61, 0
    s_cbranch_scc1 L_polla_23
    buffer_load_dword v226, v196, s[44:47], 0 offen sc1
    s_waitcnt vmcnt(0)
    v_subrev_u32 v227, s58, v226
    v_add_u32 v227, -1, v227
    v_cmp_gt_u32 vcc, 8, v227
    v_cmp_ne_u32 s[0:1], s59, v226
    s_nop 0
    s_and_b64 vcc, vcc, s[0:1]
    s_cbranch_scc0 L_polla_23
    s_mov_b32 s60, 4096
    s_add_u32 s59, s58, 9
    buffer_store_dwordx2 v[140:141], v214, s[44:47], 0 offen sc1
    buffer_store_dwordx2 v[142:143], v214, s[44:47], s25 offen sc1
    buffer_store_dwordx2 v[144:145], v214, s[44:47], s67 offen sc1
    buffer_store_dwordx2 v[146:147], v214, s[44:47], s68 offen sc1
    buffer_store_dword v148, v215, s[44:47], 0 offen sc1
    v_mov_b32 v227, s59
    s_waitcnt vmcnt(0)
    s_mov_b64 exec, 1
    buffer_store_dword v227, v197, s[44:47], s60 offen sc1
    s_mov_b64 exec, -1
L_polla_23:
    s_sleep 2
    s_cmp_lg_u32 s63, 0
    s_cbranch_scc1 L_poll_21
L_polld_22:
L_got_19:
    s_or_b32 s61, s65, s56
    s_cmp_lg_u32 s61, 0
    s_cbranch_scc1 L_nobump_24
    s_add_u32 s61, s58, 16
    v_mov_b32 v228, s61
    v_mov_b32 v229, 0
    s_mov_b64 exec, 1
    buffer_store_dword v228, v229, s[44:47], s22 offen
    s_mov_b64 exec, -1
L_nobump_24:
    buffer_load_dwordx4 v[136:139], v202, s[44:47], 0 offen offset:0 sc1
    buffer_load_dwordx4 v[140:143], v202, s[44:47], 0 offen offset:1024 sc1
    buffer_load_dwordx4 v[144:147], v202, s[44:47], 0 offen offset:2048 sc1
    buffer_load_dwordx4 v[148:151], v202, s[44:47], 0 offen offset:3072 sc1
    s_waitcnt vmcnt(3) lgkmcnt(0)
    v_mfma_f32_16x16x32_bf16 v[232:235], v[16:19], v[136:139], 0
    v_add_u32 v202, 4096, v202
    buffer_load_dwordx4 v[152:155], v202, s[44:47], 0 offen offset:0 sc1
    v_mfma_f32_16x16x32_bf16 v[236:239], v[20:23], v[136:139], 0
    ds_read_b64_tr_b16 v[16:17], v205 offset:27648
    ds_read_b64_tr_b16 v[18:19], v205 offset:27792
    v_mfma_f32_16x16x32_bf16 v[240:243], v[24:27], v[136:139], 0
    ds_read_b64_tr_b16 v[20:21], v205 offset:27680
    ds_read_b64_tr_b16 v[22:23], v205 offset:27824
    v_mfma_f32_16x16x32_bf16 v[244:247], v[28:31], v[136:139], 0
    ds_read_b64_tr_b16 v[24:25], v205 offset:27712
    ds_read_b64_tr_b16 v[26:27], v205 offset:27856
    v_mfma_f32_16x16x32_bf16 v[248:251], v[32:35], v[136:139], 0
    ds_read_b64_tr_b16 v[28:29], v205 offset:27744
    ds_read_b64_tr_b16 v[30:31], v205 offset:27888
    ds_read_b64_tr_b16 v[32:33], v205 offset:27776
    ds_read_b64_tr_b16 v[34:35], v205 offset:27920
    s_waitcnt vmcnt(3)
    v_mfma_f32_16x16x32_bf16 v[232:235], v[36:39], v[140:143], v[232:235]
    buffer_load_dwordx4 v[156:159], v202, s[44:47], 0 offen offset:1024 sc1
    v_mfma_f32_16x16x32_bf16 v[236:239], v[40:43], v[140:143], v[236:239]
    ds_read_b64_tr_b16 v[36:37], v205 offset:32256
    ds_read_b64_tr_b16 v[38:39], v205 offset:32400
    v_mfma_f32_16x16x32_bf16 v[240:243], v[44:47], v[140:143], v[240:243]
    ds_read_b64_tr_b16 v[40:41], v205 offset:32288
    ds_read_b64_tr_b16 v[42:43], v205 offset:32432
    v_mfma_f32_16x16x32_bf16 v[244:247], v[48:51], v[140:143], v[244:247]
    ds_read_b64_tr_b16 v[44:45], v205 offset:32320
    ds_read_b64_tr_b16 v[46:47], v205 offset:32464
    v_mfma_f32_16x16x32_bf16 v[248:251], v[52:55], v[140:143], v[248:251]
    ds_read_b64_tr_b16 v[48:49], v205 offset:32352
    ds_read_b64_tr_b16 v[50:51], v205 offset:32496
    ds_read_b64_tr_b16 v[52:53], v205 offset:32384
    ds_read_b64_tr_b16 v[54:55], v205 offset:32528
    s_waitcnt vmcnt(3)
    v_mfma_f32_16x16x32_bf16 v[232:235], v[56:59], v[144:147], v[232:235]
    buffer_load_dwordx4 v[160:163], v202, s[44:47], 0 offen offset:2048 sc1
    v_mfma_f32_16x16x32_bf16 v[236:239], v[60:63], v[144:147], v[236:239]
    ds_read_b64_tr_b16 v[56:57], v205 offset:36864
    ds_read_b64_tr_b16 v[58:59], v205 offset:37008
    v_mfma_f32_16x16x32_bf16 v[240:243], v[64:67], v[144:147], v[240:243]
    ds_read_b64_tr_b16 v[60:61], v205 offset:36896
    ds_read_b64_tr_b16 v[62:63], v205 offset:37040
    v_mfma_f32_16x16x32_bf16 v[244:247], v[68:71], v[144:147], v[244:247]
    ds_read_b64_tr_b16 v[64:65], v205 offset:36928
    ds_read_b64_tr_b16 v[66:67], v205 offset:37072
    v_mfma_f32_16x16x32_bf16 v[248:251], v[72:75], v[144:147], v[248:251]
    ds_read_b64_tr_b16 v[68:69], v205 offset:36960
    ds_read_b64_tr_b16 v[70:71], v205 offset:37104
    ds_read_b64_tr_b16 v[72:73], v205 offset:36992
    ds_read_b64_tr_b16 v[74:75], v205 offset:37136
    s_waitcnt vmcnt(3)
    v_mfma_f32_16x16x32_bf16 v[232:235], v[76:79], v[148:151], v[232:235]
    buffer_load_dwordx4 v[164:167], v202, s[44:47], 0 offen offset:3072 sc1
    v_mfma_f32_16x16x32_bf16 v[236:239], v[80:83], v[148:151], v[236:239]
    ds_read_b64_tr_b16 v[76:77], v205 offset:41472
    ds_read_b64_tr_b16 v[78:79], v205 offset:41616
    v_mfma_f32_16x16x32_bf16 v[240:243], v[84:87], v[148:151], v[240:243]
    ds_read_b64_tr_b16 v[80:81], v205 offset:41504
    ds_read_b64_tr_b16 v[82:83], v205 offset:41648
    v_mfma_f32_16x16x32_bf16 v[244:247], v[88:91], v[148:151], v[244:247]
    ds_read_b64_tr_b16 v[84:85], v205 offset:41536
    ds_read_b64_tr_b16 v[86:87], v205 offset:41680
    v_mfma_f32_16x16x32_bf16 v[248:251], v[92:95], v[148:151], v[248:251]
    ds_read_b64_tr_b16 v[88:89], v205 offset:41568
    ds_read_b64_tr_b16 v[90:91], v205 offset:41712
    ds_read_b64_tr_b16 v[92:93], v205 offset:41600
    ds_read_b64_tr_b16 v[94:95], v205 offset:41744
    s_waitcnt vmcnt(3)
    v_mfma_f32_16x16x32_bf16 v[232:235], v[96:99], v[152:155], v[232:235]
    v_add_u32 v202, 4096, v202
    buffer_load_dwordx4 v[168:171], v202, s[44:47], 0 offen offset:0 sc1
    v_mfma_f32_16x16x32_bf16 v[236:239], v[100:103], v[152:155], v[236:239]
    ds_read_b64_tr_b16 v[96:97], v205 offset:46080
    ds_read_b64_tr_b16 v[98:99], v205 offset:46224
    v_mfma_f32_16x16x32_bf16 v[240:243], v[104:107], v[152:155], v[240:243]
    ds_read_b64_tr_b16 v[100:101], v205 offset:46112
    ds_read_b64_tr_b16 v[102:103], v205 offset:46256
    v_mfma_f32_16x16x32_bf16 v[244:247], v[108:111], v[152:155], v[244:247]
    ds_read_b64_tr_b16 v[104:105], v205 offset:46144
    ds_read_b64_tr_b16 v[106:107], v205 offset:46288
    v_mfma_f32_16x16x32_bf16 v[248:251], v[112:115], v[152:155], v[248:251]
    ds_read_b64_tr_b16 v[108:109], v205 offset:46176
    ds_read_b64_tr_b16 v[110:111], v205 offset:46320
    ds_read_b64_tr_b16 v[112:113], v205 offset:46208
    ds_read_b64_tr_b16 v[114:115], v205 offset:46352
    s_waitcnt vmcnt(3)
    v_mfma_f32_16x16x32_bf16 v[232:235], v[116:119], v[156:159], v[232:235]
    buffer_load_dwordx4 v[172:175], v202, s[44:47], 0 offen offset:1024 sc1
    v_mfma_f32_16x16x32_bf16 v[236:239], v[120:123], v[156:159], v[236:239]
    ds_read_b64_tr_b16 v[116:117], v205 offset:50688
    ds_read_b64_tr_b16 v[118:119], v205 offset:50832
    v_mfma_f32_16x16x32_bf16 v[240:243], v[124:127], v[156:159], v[240:243]
    ds_read_b64_tr_b16 v[120:121], v205 offset:50720
    ds_read_b64_tr_b16 v[122:123], v205 offset:50864
    v_mfma_f32_16x16x32_bf16 v[244:247], v[128:131], v[156:159], v[244:247]
    ds_read_b64_tr_b16 v[124:125], v205 offset:50752
    ds_read_b64_tr_b16 v[126:127], v205 offset:50896
    v_mfma_f32_16x16x32_bf16 v[248:251], v[132:135], v[156:159], v[248:251]
    ds_read_b64_tr_b16 v[128:129], v205 offset:50784
    ds_read_b64_tr_b16 v[130:131], v205 offset:50928
    ds_read_b64_tr_b16 v[132:133], v205 offset:50816
    ds_read_b64_tr_b16 v[134:135], v205 offset:50960
    s_waitcnt vmcnt(3) lgkmcnt(10)
    v_mfma_f32_16x16x32_bf16 v[232:235], v[16:19], v[160:163], v[232:235]
    buffer_load_dwordx4 v[176:179], v202, s[44:47], 0 offen offset:2048 sc1
    v_mfma_f32_16x16x32_bf16 v[236:239], v[20:23], v[160:163], v[236:239]
    ds_read_b64_tr_b16 v[16:17], v205 offset:55296
    ds_read_b64_tr_b16 v[18:19], v205 offset:55440
    v_mfma_f32_16x16x32_bf16 v[240:243], v[24:27], v[160:163], v[240:243]
    ds_read_b64_tr_b16 v[20:21], v205 offset:55328
    ds_read_b64_tr_b16 v[22:23], v205 offset:55472
    v_mfma_f32_16x16x32_bf16 v[244:247], v[28:31], v[160:163], v[244:247]
    ds_read_b64_tr_b16 v[24:25], v205 offset:55360
    ds_read_b64_tr_b16 v[26:27], v205 offset:55504
    v_mfma_f32_16x16x32_bf16 v[248:251], v[32:35], v[160:163], v[248:251]
    ds_read_b64_tr_b16 v[28:29], v205 offset:55392
    ds_read_b64_tr_b16 v[30:31], v205 offset:55536
    ds_read_b64_tr_b16 v[32:33], v205 offset:55424
    ds_read_b64_tr_b16 v[34:35], v205 offset:55568
    s_waitcnt vmcnt(3) lgkmcnt(10)
    v_mfma_f32_16x16x32_bf16 v[232:235], v[36:39], v[164:167], v[232:235]
    buffer_load_dwordx4 v[180:183], v202, s[44:47], 0 offen offset:3072 sc1
    v_mfma_f32_16x16x32_bf16 v[236:239], v[40:43], v[164:167], v[236:239]
    ds_read_b64_tr_b16 v[36:37], v205 offset:59904
    ds_read_b64_tr_b16 v[38:39], v205 offset:60048
    v_mfma_f32_16x16x32_bf16 v[240:243], v[44:47], v[164:167], v[240:243]
    ds_read_b64_tr_b16 v[40:41], v205 offset:59936
    ds_read_b64_tr_b16 v[42:43], v205 offset:60080
    v_mfma_f32_16x16x32_bf16 v[244:247], v[48:51], v[164:167], v[244:247]
    ds_read_b64_tr_b16 v[44:45], v205 offset:59968
    ds_read_b64_tr_b16 v[46:47], v205 offset:60112
    v_mfma_f32_16x16x32_bf16 v[248:251], v[52:55], v[164:167], v[248:251]
    ds_read_b64_tr_b16 v[48:49], v205 offset:60000
    ds_read_b64_tr_b16 v[50:51], v205 offset:60144
    ds_read_b64_tr_b16 v[52:53], v205 offset:60032
    ds_read_b64_tr_b16 v[54:55], v205 offset:60176
    s_waitcnt vmcnt(3) lgkmcnt(10)
    v_mfma_f32_16x16x32_bf16 v[232:235], v[56:59], v[168:171], v[232:235]
    v_add_u32 v202, 4096, v202
    buffer_load_dwordx4 v[184:187], v202, s[44:47], 0 offen offset:0 sc1
    v_mfma_f32_16x16x32_bf16 v[236:239], v[60:63], v[168:171], v[236:239]
    ds_read_b64_tr_b16 v[56:57], v206 offset:0
    ds_read_b64_tr_b16 v[58:59], v206 offset:144
    v_mfma_f32_16x16x32_bf16 v[240:243], v[64:67], v[168:171], v[240:243]
    ds_read_b64_tr_b16 v[60:61], v206 offset:32
    ds_read_b64_tr_b16 v[62:63], v206 offset:176
    v_mfma_f32_16x16x32_bf16 v[244:247], v[68:71], v[168:171], v[244:247]
    ds_read_b64_tr_b16 v[64:65], v206 offset:64
    ds_read_b64_tr_b16 v[66:67], v206 offset:208
    v_mfma_f32_16x16x32_bf16 v[248:251], v[72:75], v[168:171], v[248:251]
    ds_read_b64_tr_b16 v[68:69], v206 offset:96
    ds_read_b64_tr_b16 v[70:71], v206 offset:240
    ds_read_b64_tr_b16 v[72:73], v206 offset:128
    ds_read_b64_tr_b16 v[74:75], v206 offset:272
    s_waitcnt vmcnt(3) lgkmcnt(10)
    v_mfma_f32_16x16x32_bf16 v[232:235], v[76:79], v[172:175], v[232:235]
    buffer_load_dwordx4 v[188:191], v202, s[44:47], 0 offen offset:1024 sc1
    v_mfma_f32_16x16x32_bf16 v[236:239], v[80:83], v[172:175], v[236:239]
    ds_read_b64_tr_b16 v[76:77], v206 offset:4608
    ds_read_b64_tr_b16 v[78:79], v206 offset:4752
    v_mfma_f32_16x16x32_bf16 v[240:243], v[84:87], v[172:175], v[240:243]
    ds_read_b64_tr_b16 v[80:81], v206 offset:4640
    ds_read_b64_tr_b16 v[82:83], v206 offset:4784
    v_mfma_f32_16x16x32_bf16 v[244:247], v[88:91], v[172:175], v[244:247]
    ds_read_b64_tr_b16 v[84:85], v206 offset:4672
    ds_read_b64_tr_b16 v[86:87], v206 offset:4816
    v_mfma_f32_16x16x32_bf16 v[248:251], v[92:95], v[172:175], v[248:251]
    ds_read_b64_tr_b16 v[88:89], v206 offset:4704
    ds_read_b64_tr_b16 v[90:91], v206 offset:4848
    ds_read_b64_tr_b16 v[92:93], v206 offset:4736
    ds_read_b64_tr_b16 v[94:95], v206 offset:4880
    s_waitcnt vmcnt(3) lgkmcnt(10)
    v_mfma_f32_16x16x32_bf16 v[232:235], v[96:99], v[176:179], v[232:235]
    buffer_load_dwordx4 v[192:195], v202, s[44:47], 0 offen offset:2048 sc1
    v_mfma_f32_16x16x32_bf16 v[236:239], v[100:103], v[176:179], v[236:239]
    ds_read_b64_tr_b16 v[96:97], v206 offset:9216
    ds_read_b64_tr_b16 v[98:99], v206 offset:9360
    v_mfma_f32_16x16x32_bf16 v[240:243], v[104:107], v[176:179], v[240:243]
    ds_read_b64_tr_b16 v[100:101], v206 offset:9248
    ds_read_b64_tr_b16 v[102:103], v206 offset:9392
    v_mfma_f32_16x16x32_bf16 v[244:247], v[108:111], v[176:179], v[244:247]
    ds_read_b64_tr_b16 v[104:105], v206 offset:9280
    ds_read_b64_tr_b16 v[106:107], v206 offset:9424
    v_mfma_f32_16x16x32_bf16 v[248:251], v[112:115], v[176:179], v[248:251]
    ds_read_b64_tr_b16 v[108:109], v206 offset:9312
    ds_read_b64_tr_b16 v[110:111], v206 offset:9456
    ds_read_b64_tr_b16 v[112:113], v206 offset:9344
    ds_read_b64_tr_b16 v[114:115], v206 offset:9488
    s_waitcnt vmcnt(3) lgkmcnt(10)
    v_mfma_f32_16x16x32_bf16 v[232:235], v[116:119], v[180:183], v[232:235]
    buffer_load_dwordx4 v[220:223], v202, s[44:47], 0 offen offset:3072 sc1
    v_mfma_f32_16x16x32_bf16 v[236:239], v[120:123], v[180:183], v[236:239]
    ds_read_b64_tr_b16 v[116:117], v206 offset:13824
    ds_read_b64_tr_b16 v[118:119], v206 offset:13968
    v_mfma_f32_16x16x32_bf16 v[240:243], v[124:127], v[180:183], v[240:243]
    ds_read_b64_tr_b16 v[120:121], v206 offset:13856
    ds_read_b64_tr_b16 v[122:123], v206 offset:14000
    v_mfma_f32_16x16x32_bf16 v[244:247], v[128:131], v[180:183], v[244:247]
    ds_read_b64_tr_b16 v[124:125], v206 offset:13888
    ds_read_b64_tr_b16 v[126:127], v206 offset:14032
    v_mfma_f32_16x16x32_bf16 v[248:251], v[132:135], v[180:183], v[248:251]
    ds_read_b64_tr_b16 v[128:129], v206 offset:13920
    ds_read_b64_tr_b16 v[130:131], v206 offset:14064
    ds_read_b64_tr_b16 v[132:133], v206 offset:13952
    ds_read_b64_tr_b16 v[134:135], v206 offset:14096
    s_waitcnt vmcnt(3) lgkmcnt(10)
    v_mfma_f32_16x16x32_bf16 v[232:235], v[16:19], v[184:187], v[232:235]
    v_add_u32 v202, 4096, v202
    buffer_load_dwordx4 v[252:255], v202, s[44:47], 0 offen offset:0 sc1
    v_mfma_f32_16x16x32_bf16 v[236:239], v[20:23], v[184:187], v[236:239]
    v_mfma_f32_16x16x32_bf16 v[240:243], v[24:27], v[184:187], v[240:243]
    v_mfma_f32_16x16x32_bf16 v[244:247], v[28:31], v[184:187], v[244:247]
    v_mfma_f32_16x16x32_bf16 v[248:251], v[32:35], v[184:187], v[248:251]
    s_waitcnt vmcnt(3) lgkmcnt(0)
    v_mfma_f32_16x16x32_bf16 v[232:235], v[36:39], v[188:191], v[232:235]
    buffer_load_dwordx4 v[8:11], v202, s[44:47], 0 offen offset:1024 sc1
    v_mfma_f32_16x16x32_bf16 v[236:239], v[40:43], v[188:191], v[236:239]
    v_mfma_f32_16x16x32_bf16 v[240:243], v[44:47], v[188:191], v[240:243]
    v_mfma_f32_16x16x32_bf16 v[244:247], v[48:51], v[188:191], v[244:247]
    v_mfma_f32_16x16x32_bf16 v[248:251], v[52:55], v[188:191], v[248:251]
    s_waitcnt vmcnt(3)
    v_mfma_f32_16x16x32_bf16 v[232:235], v[56:59], v[192:195], v[232:235]
    v_mfma_f32_16x16x32_bf16 v[236:239], v[60:63], v[192:195], v[236:239]
    v_mfma_f32_16x16x32_bf16 v[240:243], v[64:67], v[192:195], v[240:243]
    v_mfma_f32_16x16x32_bf16 v[244:247], v[68:71], v[192:195], v[244:247]
    v_mfma_f32_16x16x32_bf16 v[248:251], v[72:75], v[192:195], v[248:251]
    s_waitcnt vmcnt(2)
    v_mfma_f32_16x16x32_bf16 v[232:235], v[76:79], v[220:223], v[232:235]
    v_mfma_f32_16x16x32_bf16 v[236:239], v[80:83], v[220:223], v[236:239]
    v_mfma_f32_16x16x32_bf16 v[240:243], v[84:87], v[220:223], v[240:243]
    v_mfma_f32_16x16x32_bf16 v[244:247], v[88:91], v[220:223], v[244:247]
    v_mfma_f32_16x16x32_bf16 v[248:251], v[92:95], v[220:223], v[248:251]
    s_waitcnt vmcnt(1)
    v_mfma_f32_16x16x32_bf16 v[232:235], v[96:99], v[252:255], v[232:235]
    v_mfma_f32_16x16x32_bf16 v[236:239], v[100:103], v[252:255], v[236:239]
    v_mfma_f32_16x16x32_bf16 v[240:243], v[104:107], v[252:255], v[240:243]
    v_mfma_f32_16x16x32_bf16 v[244:247], v[108:111], v[252:255], v[244:247]
    v_mfma_f32_16x16x32_bf16 v[248:251], v[112:115], v[252:255], v[248:251]
    s_waitcnt vmcnt(0)
    v_mfma_f32_16x16x32_bf16 v[232:235], v[116:119], v[8:11], v[232:235]
    v_mfma_f32_16x16x32_bf16 v[236:239], v[120:123], v[8:11], v[236:239]
    v_mfma_f32_16x16x32_bf16 v[240:243], v[124:127], v[8:11], v[240:243]
    v_mfma_f32_16x16x32_bf16 v[244:247], v[128:131], v[8:11], v[244:247]
    v_mfma_f32_16x16x32_bf16 v[248:251], v[132:135], v[8:11], v[248:251]
    s_nop 3
    v_cvt_pk_bf16_f32 v16, v232, v233
    v_cvt_pk_bf16_f32 v17, v234, v235
    ds_write_b64 v231, v[16:17] offset:0
    v_cvt_pk_bf16_f32 v18, v236, v237
    v_cvt_pk_bf16_f32 v19, v238, v239
    ds_write_b64 v231, v[18:19] offset:32
    v_cvt_pk_bf16_f32 v20, v240, v241
    v_cvt_pk_bf16_f32 v21, v242, v243
    ds_write_b64 v231, v[20:21] offset:64
    v_cvt_pk_bf16_f32 v22, v244, v245
    v_cvt_pk_bf16_f32 v23, v246, v247
    ds_write_b64 v231, v[22:23] offset:96
    v_cvt_pk_bf16_f32 v24, v248, v249
    v_cvt_pk_bf16_f32 v25, v250, v251
    s_mov_b32 exec_hi, 0
    ds_write_b64 v231, v[24:25] offset:128
    s_mov_b32 exec_hi, -1
    s_waitcnt lgkmcnt(0)
    ds_read_b128 v[32:35], v230 offset:0
    ds_read_b128 v[36:39], v230 offset:1024
    ds_read_b128 v[40:43], v230 offset:2048
    s_waitcnt lgkmcnt(2)
    buffer_store_dwordx4 v[32:35], v203, s[40:43], 0 offen nt
    s_waitcnt lgkmcnt(1)
    buffer_store_dwordx4 v[36:39], v204, s[40:43], 0 offen nt
    s_waitcnt lgkmcnt(0)
    s_mov_b64 exec, 0xffff
    buffer_store_dwordx4 v[40:43], v219, s[40:43], 0 offen nt
    s_endpgm
L_roleA:
    s_and_b32 s64, s2, 7
    s_bfe_u32 s65, s2, 0x40003
    s_lshr_b32 s3, s56, 2
    s_lshl_b32 s3, s3, 4
    s_add_u32 s65, s65, s3
    s_and_b32 s56, s56, 3
    v_and_b32 v0, 255, v0
    s_cmp_ge_u32 s65, 4
    s_cbranch_scc1 L_noct_25
    s_cmp_lg_u32 s56, 3
    s_cbranch_scc1 L_w3_26
    s_getpc_b64 s[68:69]
L_pcref:
    s_sub_u32 s68, s68, L_pcref-concat_heads__ssm_conv_h3__sliding_local_dilated__prompt_kernel
    s_subb_u32 s69, s69, 0
    s_and_b32 s61, s65, 3
    s_lshl_b32 s61, s61, 13
    v_lshlrev_b32 v224, 7, v1
    v_add_u32 v224, s61, v224
    v_min_u32 v224, L_end-concat_heads__ssm_conv_h3__sliding_local_dilated__prompt_kernel, v224
    global_load_dword v230, v224, s[68:69]
L_w3_26:
L_noct_25:
    s_mul_i32 s61, s65, 3
    s_lshl_b32 s62, s65, 1
    s_add_u32 s62, s62, 8
    s_cmp_lt_u32 s65, 8
    s_cselect_b32 s66, s61, s62
    s_cselect_b32 s67, 3, 2
    s_mul_i32 s61, s64, 72
    s_add_u32 s66, s66, s61
    s_lshl_b32 s61, s65, 6
    s_cmp_lt_u32 s56, 2
    s_cselect_b32 s62, 4, 0
    s_sub_u32 s61, s61, s62
    s_mul_i32 s61, s61, 1152
    s_mul_i32 s63, s64, 144
    s_add_u32 s61, s61, s63
    s_and_b32 s62, s56, 1
    s_mul_i32 s62, s62, 320
    v_add_u32 v224, s62, v1
    v_mul_u32_u24 v225, 7282, v224
    v_lshrrev_b32 v225, 16, v225
    v_mul_u32_u24 v225, 1008, v225
    v_lshl_add_u32 v225, v224, 4, v225
    v_add_u32 v2, s61, v225
    v_add_u32 v224, 64, v224
    v_mul_u32_u24 v225, 7282, v224
    v_lshrrev_b32 v225, 16, v225
    v_mul_u32_u24 v225, 1008, v225
    v_lshl_add_u32 v225, v224, 4, v225
    v_add_u32 v3, s61, v225
    v_add_u32 v224, 64, v224
    v_mul_u32_u24 v225, 7282, v224
    v_lshrrev_b32 v225, 16, v225
    v_mul_u32_u24 v225, 1008, v225
    v_lshl_add_u32 v225, v224, 4, v225
    v_add_u32 v4, s61, v225
    v_add_u32 v224, 64, v224
    v_mul_u32_u24 v225, 7282, v224
    v_lshrrev_b32 v225, 16, v225
    v_mul_u32_u24 v225, 1008, v225
    v_lshl_add_u32 v225, v224, 4, v225
    v_add_u32 v5, s61, v225
    v_add_u32 v224, 64, v224
    v_mul_u32_u24 v225, 7282, v224
    v_lshrrev_b32 v225, 16, v225
    v_mul_u32_u24 v225, 1008, v225
    v_lshl_add_u32 v225, v224, 4, v225
    v_add_u32 v6, s61, v225
    s_cmp_lt_u32 s56, 2
    s_cselect_b32 s62, 36, 0
    s_add_u32 s62, s62, 576
    v_mov_b32 v225, 1073741824
    v_cmp_le_u32 vcc, s62, v224
    s_nop 1
    v_cndmask_b32 v6, v6, v225, vcc
    v_lshrrev_b32 v224, 2, v0
    v_mul_u32_u24 v225, 3641, v224
    v_lshrrev_b32 v225, 16, v225
    v_mul_u32_u24 v226, 72, v225
    v_sub_u32 v226, v0, v226
    s_mul_i32 s3, s64, 576
    v_lshlrev_b32 v228, 3, v226
    v_add_u32 v228, s3, v228
    v_lshlrev_b32 v30, 4, v1
    s_lshl_b32 s3, s64, 7
    s_add_u32 s3, s3, 7079936
    s_lshr_b32 s68, s65, 4
    s_mul_i32 s68, s68, 81920
    s_mul_i32 s61, s56, 5120
    s_add_u32 s61, s61, s68
    s_add_u32 m0, s61, 49936
    s_cmp_lt_u32 s56, 2
    s_waitcnt lgkmcnt(0)
    s_cselect_b32 s28, s6, s8
    s_cselect_b32 s29, s7, s9
    s_mov_b32 s30, 2359296
    s_mov_b32 s31, 0x20000
    buffer_load_dwordx4 v2, s[28:31], 0 offen lds
    s_add_u32 m0, m0, 1024
    s_nop 0
    buffer_load_dwordx4 v3, s[28:31], 0 offen lds
    s_add_u32 m0, m0, 1024
    s_nop 0
    buffer_load_dwordx4 v4, s[28:31], 0 offen lds
    s_add_u32 m0, m0, 1024
    s_nop 0
    buffer_load_dwordx4 v5, s[28:31], 0 offen lds
    s_add_u32 m0, m0, 1024
    s_nop 0
    buffer_load_dwordx4 v6, s[28:31], 0 offen lds
    s_mov_b32 s44, s26
    s_mov_b32 s45, s27
    s_mov_b32 s46, 16777216
    s_mov_b32 s47, 0x20000
    s_mov_b32 s48, s10
    s_mov_b32 s49, s11
    s_mov_b32 s50, 4608
    s_mov_b32 s51, 0x20000
    v_mov_b32 v17, v228
    s_mov_b32 s32, s12
    s_mov_b32 s33, s13
    s_mov_b32 s34, 2359296
    s_mov_b32 s35, 0x20000
    s_mov_b32 s40, s22
    s_mov_b32 s41, s23
    s_mov_b32 s42, 4718592
    s_mov_b32 s43, 0x20000
    s_mov_b32 s36, s4
    s_mov_b32 s37, s5
    s_mov_b32 s38, 2359296
    s_mov_b32 s39, 0x20000
    s_mov_b32 s52, s14
    s_mov_b32 s53, s15
    s_mov_b32 s54, 1152
    s_mov_b32 s55, 0x20000
    s_mov_b32 s22, s68
    s_mov_b32 s4, s3
    s_add_u32 s14, s66, s56
    s_lshl_b32 s14, s14, 12
    s_lshl_b32 s15, s66, 12
    s_lshl_b32 s61, s65, 13
    v_lshlrev_b32 v223, 7, v1
    v_add_u32 v231, s61, v223
    v_cmp_gt_u32 s[8:9], 54, v224
    v_mul_u32_u24 v226, 144, v226
    v_mul_u32_u24 v225, 48, v225
    v_sub_u32 v226, v226, v225
    s_add_u32 s23, s22, 70496
    v_add_u32 v8, s23, v226
    v_and_b32 v227, 3, v1
    v_lshrrev_b32 v224, 4, v0
    v_lshl_add_u32 v224, v224, 2, v227
    v_mul_u32_u24 v225, 3641, v224
    v_lshrrev_b32 v225, 16, v225
    v_mul_u32_u24 v225, 3312, v225
    v_lshl_add_u32 v225, v224, 3, v225
    v_bfe_u32 v224, v1, 2, 2
    v_mul_u32_u24 v226, 144, v224
    v_add_u32 v225, v225, v226
    s_add_u32 s23, s22, 49936
    v_add_u32 v7, s23, v225
    s_lshl_b32 s61, s56, 5
    v_lshlrev_b32 v225, 3, v227
    v_add3_u32 v225, v225, v226, s61
    s_add_u32 s23, s22, 79632
    v_add_u32 v12, s23, v225
    v_lshrrev_b32 v226, 4, v1
    v_mul_u32_u24 v228, 1152, v226
    v_add_u32 v225, v225, v228
    s_add_u32 s23, s22, 70416
    v_add_u32 v11, s23, v225
    v_mul_u32_u24 v225, 4160, v227
    v_add3_u32 v228, v224, v226, 1
    v_lshl_add_u32 v24, v228, 4, v225
    v_add_u32 v24, s22, v24
    v_and_b32 v224, 1, v1
    v_mul_u32_u24 v224, 4640, v224
    v_bfe_u32 v225, v1, 1, 3
    v_lshl_add_u32 v224, v225, 6, v224
    v_lshlrev_b32 v228, 4, v226
    v_sub_u32 v224, v228, v224
    s_add_u32 s23, s22, 55024
    v_add_u32 v25, s23, v224
    v_mov_b32 v23, 0
    buffer_load_dword v22, v23, s[44:47], s4 offen sc1
    buffer_load_dwordx2 v[16:17], v17, s[48:51], 0 offen
    s_cmp_lg_u32 s56, 3
    s_cbranch_scc1 L_w3_27
    s_mul_i32 s61, s65, 60
    v_add_u32 v227, s61, v1
    v_mul_u32_u24 v228, 9363, v227
    v_lshrrev_b32 v228, 16, v228
    v_mul_u32_u24 v228, 256, v228
    v_lshl_add_u32 v228, v227, 7, v228
    s_mul_i32 s61, s64, 294912
    s_sub_u32 s61, s61, 18176
    v_add_u32 v228, s61, v228
    s_mov_b32 s24, s16
    s_mov_b32 s25, s17
    s_mov_b32 s26, 2359296
    s_mov_b32 s27, 0x20000
    buffer_load_dword v230, v228, s[24:27], 0 offen
    s_mov_b32 s24, s18
    s_mov_b32 s25, s19
    s_mov_b32 s26, 1990656
    s_mov_b32 s27, 0x20000
    s_mov_b32 s13, 524288
    buffer_load_dword v230, v231, s[24:27], s13 offen
    s_mov_b32 s13, 786432
    buffer_load_dword v230, v231, s[24:27], s13 offen
L_w3_27:
    v_lshrrev_b32 v226, 4, v1
    v_lshlrev_b32 v228, 4, v226
    s_lshl_b32 s61, s65, 6
    s_add_u32 s61, s61, 63
    s_lshl_b32 s62, s56, 4
    s_sub_u32 s61, s61, s62
    v_and_b32 v229, 15, v1
    v_sub_u32 v225, s61, v229
    v_add_u32 v15, s63, v228
    buffer_load_dwordx4 v[184:187], v15, s[52:55], 0 offen
    buffer_load_dwordx4 v[188:191], v15, s[52:55], 0 offen offset:64
    buffer_load_dwordx4 v[192:195], v15, s[52:55], 0 offen offset:128
    v_and_b32 v225, 63, v225
    v_mul_u32_u24 v225, 144, v225
    s_add_u32 s23, s22, 60304
    v_add_u32 v14, s23, v225
    v_add_u32 v13, v228, v14
    v_mov_b32 v228, 1073741824
    s_mov_b64 vcc, 0xffff
    v_cmp_eq_u32 vcc, 63, v1
    v_lshlrev_b32 v229, 2, v229
    v_lshl_add_u32 v229, v226, 7, v229
    v_sub_u32 v222, 444, v229
    v_add_u32 v222, s22, v222
    v_add_u32 v221, s22, v30
    v_cndmask_b32 v31, v30, v228, vcc
    s_mul_i32 s61, s56, 9280
    s_add_u32 s61, s61, 49936
    s_add_u32 s61, s61, s22
    v_add_u32 v220, s61, v30
    s_sub_u32 s61, 3, s56
    s_mul_i32 s62, s61, 2304
    s_add_u32 s62, s62, 60176
    s_add_u32 s62, s62, s22
    v_add_u32 v241, s62, v30
    s_lshl_b32 s61, s61, 4
    s_lshl_b32 s62, s65, 6
    s_add_u32 s61, s61, s62
    s_mul_i32 s61, s61, 2304
    s_add_u32 s61, s61, s63
    v_add_u32 v225, 0, v1
    v_mul_u32_u24 v226, 7282, v225
    v_lshrrev_b32 v226, 16, v226
    v_mul_u32_u24 v226, 2160, v226
    v_lshl_add_u32 v226, v225, 4, v226
    v_add_u32 v28, s61, v226
    v_add_u32 v225, 64, v1
    v_mul_u32_u24 v226, 7282, v225
    v_lshrrev_b32 v226, 16, v226
    v_mul_u32_u24 v226, 2160, v226
    v_lshl_add_u32 v226, v225, 4, v226
    v_add_u32 v29, s61, v226
    v_add_u32 v225, 128, v1
    v_mul_u32_u24 v226, 7282, v225
    v_lshrrev_b32 v226, 16, v226
    v_mul_u32_u24 v226, 2160, v226
    v_lshl_add_u32 v226, v225, 4, v226
    v_add_u32 v240, s61, v226
    v_lshrrev_b32 v225, 4, v0
    v_and_b32 v226, 15, v0
    v_and_b32 v228, 3, v225
    v_add_u32 v228, v228, v226
    v_mul_u32_u24 v225, 4160, v225
    v_lshl_add_u32 v225, v226, 2, v225
    v_add_u32 v225, s22, v225
    v_cmp_gt_u32 vcc, 15, v228
    v_mov_b32 v32, 0
    v_mov_b32 v33, 0
    v_mov_b32 v34, 0
    v_mov_b32 v35, 0
    v_mov_b32 v36, 0
    v_mov_b32 v37, 0
    v_mov_b32 v38, 0
    v_mov_b32 v39, 0
    v_mov_b32 v40, 0
    v_mov_b32 v41, 0
    v_mov_b32 v42, 0
    v_mov_b32 v43, 0
    v_mov_b32 v44, 0
    v_mov_b32 v45, 0
    v_mov_b32 v46, 0
    v_mov_b32 v47, 0
    v_mov_b32 v48, 0
    v_mov_b32 v49, 0
    v_mov_b32 v50, 0
    v_mov_b32 v51, 0
    v_mov_b32 v52, 0
    v_mov_b32 v53, 0
    v_mov_b32 v54, 0
    v_mov_b32 v55, 0
    v_mov_b32 v56, 0
    v_mov_b32 v57, 0
    v_mov_b32 v58, 0
    v_mov_b32 v59, 0
    v_mov_b32 v60, 0
    v_mov_b32 v61, 0
    v_mov_b32 v62, 0
    v_mov_b32 v63, 0
    v_mov_b32 v64, 0
    v_mov_b32 v65, 0
    v_mov_b32 v66, 0
    v_mov_b32 v67, 0
    v_mov_b32 v68, 0
    v_mov_b32 v69, 0
    v_mov_b32 v70, 0
    v_mov_b32 v71, 0
    v_mov_b32 v72, 0
    v_mov_b32 v73, 0
    v_mov_b32 v74, 0
    v_mov_b32 v75, 0
    v_mov_b32 v76, 0
    v_mov_b32 v77, 0
    v_mov_b32 v78, 0
    v_mov_b32 v79, 0
    v_mov_b32 v80, 0
    v_mov_b32 v81, 0
    v_mov_b32 v82, 0
    v_mov_b32 v83, 0
    v_mov_b32 v84, 0
    v_mov_b32 v85, 0
    v_mov_b32 v86, 0
    v_mov_b32 v87, 0
    v_mov_b32 v88, 0
    v_mov_b32 v89, 0
    v_mov_b32 v90, 0
    v_mov_b32 v91, 0
    v_mov_b32 v92, 0
    v_mov_b32 v93, 0
    v_mov_b32 v94, 0
    v_mov_b32 v95, 0
    s_cmp_lt_u32 s56, 3
    s_cselect_b64 exec, vcc, 0
    s_cbranch_execz L_hz_28
    ds_write_b32 v225, v32 offset:16
L_hz_28:
    s_mov_b64 exec, -1
    v_lshrrev_b32 v225, 3, v1
    s_mul_i32 s61, s56, 24
    v_add_u32 v225, s61, v225
    v_and_b32 v228, 7, v1
    v_lshlrev_b32 v228, 4, v228
    v_mul_u32_u24 v9, 144, v225
    v_add_u32 v9, v9, v228
    s_add_u32 s23, s22, 70416
    v_add_u32 v9, s23, v9
    s_mul_i32 s61, s64, 294912
    s_sub_u32 s62, 31, s65
    s_lshl_b32 s62, s62, 7
    s_add_u32 s61, s61, s62
    v_lshl_add_u32 v10, v225, 12, v228
    v_add_u32 v10, s61, v10
    s_mov_b32 s6, 32768
    s_mov_b32 s7, 65536
    v_lshrrev_b32 v224, 5, v0
    v_mul_u32_u24 v224, 4640, v224
    v_and_b32 v225, 31, v0
    v_lshl_add_u32 v224, v225, 4, v224
    s_add_u32 s23, s22, 54032
    v_add_u32 v19, s23, v224
    s_lshl_b32 s61, s64, 12
    s_add_u32 s61, s61, 7114752
    s_lshl_b32 s5, s65, 7
    s_add_u32 s5, s5, s61
    v_lshlrev_b32 v228, 7, v225
    v_add_u32 v18, s61, v228
    s_lshl_b32 s61, s64, 9
    s_add_u32 s61, s61, 7155712
    v_lshlrev_b32 v228, 4, v225
    v_add_u32 v21, s61, v228
    s_lshl_b32 s62, s65, 4
    s_add_u32 s61, s61, s62
    s_lshl_b32 s62, s56, 2
    s_add_u32 s61, s61, s62
    v_mov_b32 v20, s61
    s_lshl_b32 s61, s67, 1
    s_mul_i32 s68, s61, s56
    s_and_b32 s62, s68, 7
    s_sub_u32 s69, 8, s62
    s_min_u32 s69, s69, s61
    s_sub_u32 s10, s61, s69
    s_mov_b32 s97, s10
    s_lshr_b32 s3, s68, 3
    s_lshl_b32 s11, s3, 13
    s_lshl_b32 s3, s3, 12
    s_add_u32 s12, s15, s3
    s_mov_b32 s95, s62
    s_lshr_b32 s61, s68, 3
    s_and_b32 s62, s68, 7
    s_lshl_b32 s62, s62, 6
    s_mul_i32 s3, s61, 16640
    s_add_u32 s3, s3, s62
    v_add_u32 v26, s3, v24
    s_mul_i32 s3, s61, 9280
    s_add_u32 s3, s3, s62
    v_add_u32 v27, s3, v25
    s_lshr_b32 s69, s69, 1
    s_lshr_b32 s10, s10, 1
    s_cmp_lg_u32 s56, 3
    s_cbranch_scc1 L_w3_29
    buffer_load_dword v230, v223, s[44:47], s15 offen sc1
    s_add_u32 s13, s15, 8192
    s_mov_b32 exec_hi, 0
    buffer_load_dword v230, v223, s[44:47], s13 offen sc1
    s_mov_b32 exec_hi, -1
    s_mov_b32 s24, s18
    s_mov_b32 s25, s19
    s_mov_b32 s26, 1990656
    s_mov_b32 s27, 0x20000
    s_mov_b32 s13, 1048576
    buffer_load_dword v230, v231, s[24:27], s13 offen
    s_mov_b32 s13, 1310720
    buffer_load_dword v230, v231, s[24:27], s13 offen
L_w3_29:
    s_cmp_eq_u32 s56, 3
    s_cbranch_scc1 L_kw_30
    s_waitcnt vmcnt(3)
L_kw_30:
    s_waitcnt vmcnt(10)
    s_barrier
    ds_read_b64_tr_b16 v[110:111], v7 offset:144
    ds_read_b64_tr_b16 v[96:97], v7 offset:0
    ds_read_b64_tr_b16 v[112:113], v7 offset:720
    ds_read_b64_tr_b16 v[98:99], v7 offset:576
    ds_read_b64_tr_b16 v[114:115], v7 offset:1296
    ds_read_b64_tr_b16 v[100:101], v7 offset:1152
    ds_read_b64_tr_b16 v[116:117], v7 offset:1872
    ds_read_b64_tr_b16 v[102:103], v7 offset:1728
    ds_read_b64_tr_b16 v[118:119], v7 offset:2448
    ds_read_b64_tr_b16 v[104:105], v7 offset:2304
    ds_read_b64_tr_b16 v[120:121], v7 offset:3024
    ds_read_b64_tr_b16 v[106:107], v7 offset:2880
    ds_read_b64_tr_b16 v[122:123], v7 offset:3600
    ds_read_b64_tr_b16 v[108:109], v7 offset:3456
    v_readfirstlane_b32 s58, v22
    s_nop 0
    s_add_u32 s59, s58, s57
    s_add_u32 s59, s59, 1
    s_cmp_lg_u32 s56, 3
    s_cbranch_scc1 L_noreg_31
    v_mov_b32 v22, s59
    s_mov_b64 exec, 1
    buffer_store_dword v22, v23, s[44:47], s5 offen sc1
    s_mov_b64 exec, -1
L_noreg_31:
    s_cmp_lg_u32 s56, 3
    s_cbranch_scc1 L_w3_32
    s_add_u32 s96, s15, 0
    s_add_u32 m0, s22, 76
    s_nop 0
    buffer_load_dwordx4 v30, s[32:35], s96 offen offset:0 lds
    buffer_load_dwordx4 v30, s[32:35], s96 offen offset:1024 lds
    buffer_load_dwordx4 v30, s[32:35], s96 offen offset:2048 lds
    buffer_load_dwordx4 v30, s[32:35], s96 offen offset:3072 lds
    s_add_u32 s96, s15, 4096
    s_add_u32 m0, s22, 16716
    s_nop 0
    buffer_load_dwordx4 v30, s[32:35], s96 offen offset:0 lds
    buffer_load_dwordx4 v30, s[32:35], s96 offen offset:1024 lds
    buffer_load_dwordx4 v30, s[32:35], s96 offen offset:2048 lds
    buffer_load_dwordx4 v30, s[32:35], s96 offen offset:3072 lds
    s_cmp_eq_u32 s67, 2
    s_cbranch_scc1 L_h2_33
    s_add_u32 s96, s15, 8192
    s_add_u32 m0, s22, 33356
    s_nop 0
    buffer_load_dwordx4 v30, s[32:35], s96 offen offset:0 lds
    buffer_load_dwordx4 v30, s[32:35], s96 offen offset:1024 lds
    buffer_load_dwordx4 v30, s[32:35], s96 offen offset:2048 lds
    buffer_load_dwordx4 v30, s[32:35], s96 offen offset:3072 lds
L_h2_33:
L_w3_32:
    v_alignbit_b32 v16, v16, v16, 16
    v_alignbit_b32 v17, v17, v17, 16
    ds_read_b64_tr_b16 v[128:129], v7 offset:10240
    ds_read_b64_tr_b16 v[130:131], v7 offset:10816
    ds_read_b64_tr_b16 v[132:133], v7 offset:11392
    ds_read_b64_tr_b16 v[134:135], v7 offset:11968
    ds_read_b64_tr_b16 v[136:137], v7 offset:12544
    ds_read_b64_tr_b16 v[138:139], v7 offset:13120
    s_waitcnt lgkmcnt(14)
    v_dot2_f32_bf16 v196, v110, v17, 0
    v_dot2_f32_bf16 v197, v97, v17, 0
    v_dot2_f32_bf16 v198, v111, v17, 0
    v_dot2_f32_bf16 v199, v98, v17, 0
    v_dot2_f32_bf16 v200, v112, v17, 0
    v_dot2_f32_bf16 v201, v99, v17, 0
    v_dot2_f32_bf16 v202, v113, v17, 0
    v_dot2_f32_bf16 v203, v100, v17, 0
    v_dot2_f32_bf16 v196, v111, v16, v196
    v_dot2_f32_bf16 v197, v98, v16, v197
    v_dot2_f32_bf16 v198, v112, v16, v198
    v_dot2_f32_bf16 v199, v99, v16, v199
    v_dot2_f32_bf16 v200, v113, v16, v200
    v_dot2_f32_bf16 v201, v100, v16, v201
    v_dot2_f32_bf16 v202, v114, v16, v202
    v_dot2_f32_bf16 v203, v101, v16, v203
    s_waitcnt lgkmcnt(10)
    v_dot2_f32_bf16 v204, v114, v17, 0
    v_dot2_f32_bf16 v205, v101, v17, 0
    v_dot2_f32_bf16 v206, v115, v17, 0
    v_dot2_f32_bf16 v207, v102, v17, 0
    v_dot2_f32_bf16 v208, v116, v17, 0
    v_dot2_f32_bf16 v209, v103, v17, 0
    v_dot2_f32_bf16 v210, v117, v17, 0
    v_dot2_f32_bf16 v211, v104, v17, 0
    v_dot2_f32_bf16 v204, v115, v16, v204
    v_dot2_f32_bf16 v205, v102, v16, v205
    v_dot2_f32_bf16 v206, v116, v16, v206
    v_dot2_f32_bf16 v207, v103, v16, v207
    v_dot2_f32_bf16 v208, v117, v16, v208
    v_dot2_f32_bf16 v209, v104, v16, v209
    v_dot2_f32_bf16 v210, v118, v16, v210
    v_dot2_f32_bf16 v211, v105, v16, v211
    s_waitcnt lgkmcnt(6)
    v_dot2_f32_bf16 v212, v118, v17, 0
    v_dot2_f32_bf16 v213, v105, v17, 0
    v_dot2_f32_bf16 v214, v119, v17, 0
    v_dot2_f32_bf16 v215, v106, v17, 0
    v_dot2_f32_bf16 v216, v120, v17, 0
    v_dot2_f32_bf16 v217, v107, v17, 0
    v_dot2_f32_bf16 v218, v121, v17, 0
    v_dot2_f32_bf16 v219, v108, v17, 0
    v_dot2_f32_bf16 v212, v119, v16, v212
    v_dot2_f32_bf16 v213, v106, v16, v213
    v_dot2_f32_bf16 v214, v120, v16, v214
    v_dot2_f32_bf16 v215, v107, v16, v215
    v_dot2_f32_bf16 v216, v121, v16, v216
    v_dot2_f32_bf16 v217, v108, v16, v217
    v_dot2_f32_bf16 v218, v122, v16, v218
    v_dot2_f32_bf16 v219, v109, v16, v219
    s_waitcnt lgkmcnt(0)
    s_mov_b64 exec, s[8:9]
    v_lshlrev_b32 v96, 16, v128
    v_and_b32 v97, 0xffff0000, v128
    v_lshlrev_b32 v98, 16, v129
    v_and_b32 v99, 0xffff0000, v129
    v_lshlrev_b32 v100, 16, v130
    v_and_b32 v101, 0xffff0000, v130
    v_lshlrev_b32 v102, 16, v131
    v_and_b32 v103, 0xffff0000, v131
    v_pk_mul_f32 v[196:197], v[196:197], v[96:97]
    v_pk_mul_f32 v[198:199], v[198:199], v[98:99]
    v_pk_mul_f32 v[200:201], v[200:201], v[100:101]
    v_pk_mul_f32 v[202:203], v[202:203], v[102:103]
    v_cvt_pk_bf16_f32 v140, v203, v202
    v_cvt_pk_bf16_f32 v141, v201, v200
    v_cvt_pk_bf16_f32 v142, v199, v198
    v_cvt_pk_bf16_f32 v143, v197, v196
    ds_write_b128 v8, v[140:143] offset:32
    v_lshlrev_b32 v104, 16, v132
    v_and_b32 v105, 0xffff0000, v132
    v_lshlrev_b32 v106, 16, v133
    v_and_b32 v107, 0xffff0000, v133
    v_lshlrev_b32 v108, 16, v134
    v_and_b32 v109, 0xffff0000, v134
    v_lshlrev_b32 v110, 16, v135
    v_and_b32 v111, 0xffff0000, v135
    v_pk_mul_f32 v[204:205], v[204:205], v[104:105]
    v_pk_mul_f32 v[206:207], v[206:207], v[106:107]
    v_pk_mul_f32 v[208:209], v[208:209], v[108:109]
    v_pk_mul_f32 v[210:211], v[210:211], v[110:111]
    v_cvt_pk_bf16_f32 v144, v211, v210
    v_cvt_pk_bf16_f32 v145, v209, v208
    v_cvt_pk_bf16_f32 v146, v207, v206
    v_cvt_pk_bf16_f32 v147, v205, v204
    ds_write_b128 v8, v[144:147] offset:16
    v_lshlrev_b32 v112, 16, v136
    v_and_b32 v113, 0xffff0000, v136
    v_lshlrev_b32 v114, 16, v137
    v_and_b32 v115, 0xffff0000, v137
    v_lshlrev_b32 v116, 16, v138
    v_and_b32 v117, 0xffff0000, v138
    v_lshlrev_b32 v118, 16, v139
    v_and_b32 v119, 0xffff0000, v139
    v_pk_mul_f32 v[212:213], v[212:213], v[112:113]
    v_pk_mul_f32 v[214:215], v[214:215], v[114:115]
    v_pk_mul_f32 v[216:217], v[216:217], v[116:117]
    v_pk_mul_f32 v[218:219], v[218:219], v[118:119]
    v_cvt_pk_bf16_f32 v148, v219, v218
    v_cvt_pk_bf16_f32 v149, v217, v216
    v_cvt_pk_bf16_f32 v150, v215, v214
    v_cvt_pk_bf16_f32 v151, v213, v212
    ds_write_b128 v8, v[148:151] offset:0
    s_mov_b64 exec, -1
    s_waitcnt lgkmcnt(0)
    s_barrier
    ds_read_b128 v[96:99], v9 offset:0
    ds_read_b128 v[100:103], v9 offset:1152
    ds_read_b128 v[104:107], v9 offset:2304
    ds_read_b64_tr_b16 v[160:161], v11 offset:0
    ds_read_b64_tr_b16 v[162:163], v11 offset:576
    ds_read_b64_tr_b16 v[164:165], v11 offset:4608
    ds_read_b64_tr_b16 v[166:167], v11 offset:5184
    ds_read_b64_tr_b16 v[168:169], v12 offset:0
    ds_read_b64_tr_b16 v[170:171], v12 offset:576
    s_cmp_eq_u32 s56, 3
    s_cbranch_scc1 L_xw_36
    s_waitcnt lgkmcnt(6)
    buffer_store_dwordx4 v[96:99], v10, s[44:47], 0 offen nt
    buffer_store_dwordx4 v[100:103], v10, s[44:47], s6 offen nt
    buffer_store_dwordx4 v[104:107], v10, s[44:47], s7 offen nt
    v_mov_b32 v224, s59
    s_waitcnt vmcnt(0)
    s_mov_b64 exec, 1
    buffer_store_dword v224, v20, s[44:47], 0 offen
    s_mov_b64 exec, -1
    s_waitcnt lgkmcnt(0)
    v_lshlrev_b32 v172, 16, v160
    v_and_b32 v173, 0xffff0000, v160
    v_lshlrev_b32 v226, 16, v184
    v_and_b32 v227, 0xffff0000, v184
    v_pk_mul_f32 v[172:173], v[172:173], v[226:227]
    v_lshlrev_b32 v174, 16, v161
    v_and_b32 v175, 0xffff0000, v161
    v_lshlrev_b32 v228, 16, v185
    v_and_b32 v229, 0xffff0000, v185
    v_pk_mul_f32 v[174:175], v[174:175], v[228:229]
    v_lshlrev_b32 v176, 16, v162
    v_and_b32 v177, 0xffff0000, v162
    v_lshlrev_b32 v226, 16, v186
    v_and_b32 v227, 0xffff0000, v186
    v_pk_mul_f32 v[176:177], v[176:177], v[226:227]
    v_lshlrev_b32 v178, 16, v163
    v_and_b32 v179, 0xffff0000, v163
    v_lshlrev_b32 v228, 16, v187
    v_and_b32 v229, 0xffff0000, v187
    v_pk_mul_f32 v[178:179], v[178:179], v[228:229]
    v_lshlrev_b32 v180, 16, v164
    v_and_b32 v181, 0xffff0000, v164
    v_lshlrev_b32 v226, 16, v188
    v_and_b32 v227, 0xffff0000, v188
    v_pk_mul_f32 v[180:181], v[180:181], v[226:227]
    v_lshlrev_b32 v182, 16, v165
    v_and_b32 v183, 0xffff0000, v165
    v_lshlrev_b32 v228, 16, v189
    v_and_b32 v229, 0xffff0000, v189
    v_pk_mul_f32 v[182:183], v[182:183], v[228:229]
    v_lshlrev_b32 v242, 16, v166
    v_and_b32 v243, 0xffff0000, v166
    v_lshlrev_b32 v226, 16, v190
    v_and_b32 v227, 0xffff0000, v190
    v_pk_mul_f32 v[242:243], v[242:243], v[226:227]
    v_lshlrev_b32 v244, 16, v167
    v_and_b32 v245, 0xffff0000, v167
    v_lshlrev_b32 v228, 16, v191
    v_and_b32 v229, 0xffff0000, v191
    v_pk_mul_f32 v[244:245], v[244:245], v[228:229]
    v_lshlrev_b32 v246, 16, v168
    v_and_b32 v247, 0xffff0000, v168
    v_lshlrev_b32 v226, 16, v192
    v_and_b32 v227, 0xffff0000, v192
    v_pk_mul_f32 v[246:247], v[246:247], v[226:227]
    v_lshlrev_b32 v248, 16, v169
    v_and_b32 v249, 0xffff0000, v169
    v_lshlrev_b32 v228, 16, v193
    v_and_b32 v229, 0xffff0000, v193
    v_pk_mul_f32 v[248:249], v[248:249], v[228:229]
    v_lshlrev_b32 v250, 16, v170
    v_and_b32 v251, 0xffff0000, v170
    v_lshlrev_b32 v226, 16, v194
    v_and_b32 v227, 0xffff0000, v194
    v_pk_mul_f32 v[250:251], v[250:251], v[226:227]
    v_lshlrev_b32 v252, 16, v171
    v_and_b32 v253, 0xffff0000, v171
    v_lshlrev_b32 v228, 16, v195
    v_and_b32 v229, 0xffff0000, v195
    v_pk_mul_f32 v[252:253], v[252:253], v[228:229]
    s_mov_b32 s63, 6
    buffer_load_dwordx3 v[208:210], v21, s[44:47], s60 offen sc1
    s_sleep 3
L_fp_39:
    buffer_load_dwordx3 v[212:214], v21, s[44:47], s60 offen sc1
    s_waitcnt vmcnt(1)
    v_xor_b32 v208, s59, v208
    v_xor_b32 v209, s59, v209
    v_xor_b32 v210, s59, v210
    v_or3_b32 v208, v208, v209, v210
    v_cmp_ne_u32 vcc, 0, v208
    s_cbranch_vccz L_got1_38
    buffer_load_dwordx3 v[208:210], v21, s[44:47], s60 offen sc1
    s_sub_u32 s63, s63, 1
    s_waitcnt vmcnt(1)
    v_xor_b32 v212, s59, v212
    v_xor_b32 v213, s59, v213
    v_xor_b32 v214, s59, v214
    v_or3_b32 v212, v212, v213, v214
    v_cmp_ne_u32 vcc, 0, v212
    s_cbranch_vccz L_got1_38
    s_cmp_lg_u32 s63, 0
    s_cbranch_scc1 L_fp_39
    s_waitcnt vmcnt(0)
    s_mov_b32 s63, 524288
L_poll_40:
    buffer_load_dwordx3 v[208:210], v21, s[44:47], s60 offen sc1
    s_sub_u32 s63, s63, 1
    s_waitcnt vmcnt(0)
    v_xor_b32 v208, s59, v208
    v_xor_b32 v209, s59, v209
    v_xor_b32 v210, s59, v210
    v_or3_b32 v208, v208, v209, v210
    v_cmp_ne_u32 vcc, 0, v208
    s_cbranch_vccz L_polld_41
    s_and_b32 s61, s63, 7
    s_or_b32 s61, s61, s60
    s_cmp_lg_u32 s61, 0
    s_cbranch_scc1 L_polla_42
    buffer_load_dword v208, v18, s[44:47], 0 offen sc1
    s_waitcnt vmcnt(0)
    v_subrev_u32 v224, s58, v208
    v_add_u32 v224, -1, v224
    v_cmp_gt_u32 vcc, 8, v224
    v_cmp_ne_u32 s[0:1], s59, v208
    s_nop 0
    s_and_b64 vcc, vcc, s[0:1]
    s_cbranch_scc0 L_polla_42
    s_mov_b32 s60, 4096
    s_add_u32 s59, s58, 9
    buffer_store_dwordx4 v[96:99], v10, s[44:47], 0 offen sc1
    buffer_store_dwordx4 v[100:103], v10, s[44:47], s6 offen sc1
    buffer_store_dwordx4 v[104:107], v10, s[44:47], s7 offen sc1
    v_mov_b32 v224, s59
    s_waitcnt vmcnt(0)
    s_mov_b64 exec, 1
    buffer_store_dword v224, v20, s[44:47], s60 offen sc1
    s_mov_b64 exec, -1
L_polla_42:
    s_sleep 2
    s_cmp_lg_u32 s63, 0
    s_cbranch_scc1 L_poll_40
L_polld_41:
L_got1_38:
    s_cmp_ge_u32 s56, s67
    s_cbranch_scc1 L_xd_37
    buffer_load_dwordx4 v[96:99], v30, s[44:47], s14 offen offset:0 sc1
    buffer_load_dword v100, v30, s[44:47], s14 offen offset:16 sc1
    buffer_load_dwordx4 v[108:111], v30, s[44:47], s14 offen offset:1024 sc1
    buffer_load_dword v112, v30, s[44:47], s14 offen offset:1040 sc1
    buffer_load_dwordx4 v[120:123], v30, s[44:47], s14 offen offset:2048 sc1
    buffer_load_dword v124, v30, s[44:47], s14 offen offset:2064 sc1
    buffer_load_dwordx4 v[132:135], v30, s[44:47], s14 offen offset:3072 sc1
    buffer_load_dword v136, v31, s[44:47], s14 offen offset:3088 sc1
    s_branch L_x3_34
L_xw_36:
    s_waitcnt vmcnt(0)
    s_add_u32 s96, s15, 0
    s_add_u32 m0, s22, 4232
    s_nop 0
    buffer_load_dwordx4 v30, s[32:35], s96 offen offset:0 lds
    buffer_load_dwordx4 v30, s[32:35], s96 offen offset:1024 lds
    buffer_load_dwordx4 v30, s[32:35], s96 offen offset:2048 lds
    buffer_load_dwordx4 v30, s[32:35], s96 offen offset:3072 lds
    s_add_u32 m0, s22, 8388
    s_nop 0
    buffer_load_dwordx4 v30, s[32:35], s96 offen offset:0 lds
    buffer_load_dwordx4 v30, s[32:35], s96 offen offset:1024 lds
    buffer_load_dwordx4 v30, s[32:35], s96 offen offset:2048 lds
    buffer_load_dwordx4 v30, s[32:35], s96 offen offset:3072 lds
    s_add_u32 m0, s22, 12544
    s_nop 0
    buffer_load_dwordx4 v30, s[32:35], s96 offen offset:0 lds
    buffer_load_dwordx4 v30, s[32:35], s96 offen offset:1024 lds
    buffer_load_dwordx4 v30, s[32:35], s96 offen offset:2048 lds
    buffer_load_dwordx4 v30, s[32:35], s96 offen offset:3072 lds
    s_add_u32 s96, s15, 4096
    s_add_u32 m0, s22, 20872
    s_nop 0
    buffer_load_dwordx4 v30, s[32:35], s96 offen offset:0 lds
    buffer_load_dwordx4 v30, s[32:35], s96 offen offset:1024 lds
    buffer_load_dwordx4 v30, s[32:35], s96 offen offset:2048 lds
    buffer_load_dwordx4 v30, s[32:35], s96 offen offset:3072 lds
    s_add_u32 m0, s22, 25028
    s_nop 0
    buffer_load_dwordx4 v30, s[32:35], s96 offen offset:0 lds
    buffer_load_dwordx4 v30, s[32:35], s96 offen offset:1024 lds
    buffer_load_dwordx4 v30, s[32:35], s96 offen offset:2048 lds
    buffer_load_dwordx4 v30, s[32:35], s96 offen offset:3072 lds
    s_add_u32 m0, s22, 29184
    s_nop 0
    buffer_load_dwordx4 v30, s[32:35], s96 offen offset:0 lds
    buffer_load_dwordx4 v30, s[32:35], s96 offen offset:1024 lds
    buffer_load_dwordx4 v30, s[32:35], s96 offen offset:2048 lds
    buffer_load_dwordx4 v30, s[32:35], s96 offen offset:3072 lds
    s_cmp_eq_u32 s67, 2
    s_cbranch_scc1 L_h2_43
    s_add_u32 s96, s15, 8192
    s_add_u32 m0, s22, 37512
    s_nop 0
    buffer_load_dwordx4 v30, s[32:35], s96 offen offset:0 lds
    buffer_load_dwordx4 v30, s[32:35], s96 offen offset:1024 lds
    buffer_load_dwordx4 v30, s[32:35], s96 offen offset:2048 lds
    buffer_load_dwordx4 v30, s[32:35], s96 offen offset:3072 lds
    s_add_u32 m0, s22, 41668
    s_nop 0
    buffer_load_dwordx4 v30, s[32:35], s96 offen offset:0 lds
    buffer_load_dwordx4 v30, s[32:35], s96 offen offset:1024 lds
    buffer_load_dwordx4 v30, s[32:35], s96 offen offset:2048 lds
    buffer_load_dwordx4 v30, s[32:35], s96 offen offset:3072 lds
    s_add_u32 m0, s22, 45824
    s_nop 0
    buffer_load_dwordx4 v30, s[32:35], s96 offen offset:0 lds
    buffer_load_dwordx4 v30, s[32:35], s96 offen offset:1024 lds
    buffer_load_dwordx4 v30, s[32:35], s96 offen offset:2048 lds
    buffer_load_dwordx4 v30, s[32:35], s96 offen offset:3072 lds
L_h2_43:
    s_waitcnt lgkmcnt(0)
    v_lshlrev_b32 v172, 16, v160
    v_and_b32 v173, 0xffff0000, v160
    v_lshlrev_b32 v226, 16, v184
    v_and_b32 v227, 0xffff0000, v184
    v_pk_mul_f32 v[172:173], v[172:173], v[226:227]
    v_lshlrev_b32 v174, 16, v161
    v_and_b32 v175, 0xffff0000, v161
    v_lshlrev_b32 v228, 16, v185
    v_and_b32 v229, 0xffff0000, v185
    v_pk_mul_f32 v[174:175], v[174:175], v[228:229]
    v_lshlrev_b32 v176, 16, v162
    v_and_b32 v177, 0xffff0000, v162
    v_lshlrev_b32 v226, 16, v186
    v_and_b32 v227, 0xffff0000, v186
    v_pk_mul_f32 v[176:177], v[176:177], v[226:227]
    v_lshlrev_b32 v178, 16, v163
    v_and_b32 v179, 0xffff0000, v163
    v_lshlrev_b32 v228, 16, v187
    v_and_b32 v229, 0xffff0000, v187
    v_pk_mul_f32 v[178:179], v[178:179], v[228:229]
    v_lshlrev_b32 v180, 16, v164
    v_and_b32 v181, 0xffff0000, v164
    v_lshlrev_b32 v226, 16, v188
    v_and_b32 v227, 0xffff0000, v188
    v_pk_mul_f32 v[180:181], v[180:181], v[226:227]
    v_lshlrev_b32 v182, 16, v165
    v_and_b32 v183, 0xffff0000, v165
    v_lshlrev_b32 v228, 16, v189
    v_and_b32 v229, 0xffff0000, v189
    v_pk_mul_f32 v[182:183], v[182:183], v[228:229]
    v_lshlrev_b32 v242, 16, v166
    v_and_b32 v243, 0xffff0000, v166
    v_lshlrev_b32 v226, 16, v190
    v_and_b32 v227, 0xffff0000, v190
    v_pk_mul_f32 v[242:243], v[242:243], v[226:227]
    v_lshlrev_b32 v244, 16, v167
    v_and_b32 v245, 0xffff0000, v167
    v_lshlrev_b32 v228, 16, v191
    v_and_b32 v229, 0xffff0000, v191
    v_pk_mul_f32 v[244:245], v[244:245], v[228:229]
    v_lshlrev_b32 v246, 16, v168
    v_and_b32 v247, 0xffff0000, v168
    v_lshlrev_b32 v226, 16, v192
    v_and_b32 v227, 0xffff0000, v192
    v_pk_mul_f32 v[246:247], v[246:247], v[226:227]
    v_lshlrev_b32 v248, 16, v169
    v_and_b32 v249, 0xffff0000, v169
    v_lshlrev_b32 v228, 16, v193
    v_and_b32 v229, 0xffff0000, v193
    v_pk_mul_f32 v[248:249], v[248:249], v[228:229]
    v_lshlrev_b32 v250, 16, v170
    v_and_b32 v251, 0xffff0000, v170
    v_lshlrev_b32 v226, 16, v194
    v_and_b32 v227, 0xffff0000, v194
    v_pk_mul_f32 v[250:251], v[250:251], v[226:227]
    v_lshlrev_b32 v252, 16, v171
    v_and_b32 v253, 0xffff0000, v171
    v_lshlrev_b32 v228, 16, v195
    v_and_b32 v229, 0xffff0000, v195
    v_pk_mul_f32 v[252:253], v[252:253], v[228:229]
    s_waitcnt vmcnt(0)
    s_mov_b32 s24, s18
    s_mov_b32 s25, s19
    s_mov_b32 s26, 1990656
    s_mov_b32 s27, 0x20000
    s_mov_b32 s13, 1572864
    buffer_load_dword v230, v231, s[24:27], s13 offen
    s_mov_b32 s13, 1835008
    buffer_load_dword v230, v231, s[24:27], s13 offen
    s_branch L_x3_34
L_xd_37:
    s_waitcnt vmcnt(0)
L_x3_34:
    v_mov_b32 v224, s60
    v_mov_b32 v225, 81916
    s_waitcnt lgkmcnt(0)
    s_barrier
    s_cmp_eq_u32 s56, 3
    s_cbranch_scc1 L_xj_35
    ds_write_b128 v19, v[32:35]
    s_cmp_ge_u32 s56, s67
    s_cbranch_scc1 L_xj_35
    ds_write_b32 v225, v224
    s_waitcnt vmcnt(6)
    ds_write_b128 v220, v[96:99] offset:0
    v_alignbit_b32 v104, v97, v96, 16
    v_alignbit_b32 v105, v98, v97, 16
    v_alignbit_b32 v106, v99, v98, 16
    v_alignbit_b32 v107, v100, v99, 16
    ds_write_b128 v220, v[104:107] offset:4640
    s_waitcnt vmcnt(4)
    ds_write_b128 v220, v[108:111] offset:1024
    v_alignbit_b32 v116, v109, v108, 16
    v_alignbit_b32 v117, v110, v109, 16
    v_alignbit_b32 v118, v111, v110, 16
    v_alignbit_b32 v119, v112, v111, 16
    ds_write_b128 v220, v[116:119] offset:5664
    s_waitcnt vmcnt(2)
    ds_write_b128 v220, v[120:123] offset:2048
    v_alignbit_b32 v128, v121, v120, 16
    v_alignbit_b32 v129, v122, v121, 16
    v_alignbit_b32 v130, v123, v122, 16
    v_alignbit_b32 v131, v124, v123, 16
    ds_write_b128 v220, v[128:131] offset:6688
    s_waitcnt vmcnt(0)
    ds_write_b128 v220, v[132:135] offset:3072
    v_alignbit_b32 v140, v133, v132, 16
    v_alignbit_b32 v141, v134, v133, 16
    v_alignbit_b32 v142, v135, v134, 16
    v_alignbit_b32 v143, v136, v135, 16
    ds_write_b128 v220, v[140:143] offset:7712
L_xj_35:
    s_waitcnt lgkmcnt(0)
    s_barrier
    ds_read_b32 v224, v225
    ds_read_b128 v[96:99], v26 offset:0
    ds_read_b128 v[156:159], v27 offset:0
    ds_read_b128 v[152:155], v27 offset:512
    ds_read_b128 v[148:151], v27 offset:1024
    ds_read_b128 v[144:147], v27 offset:1536
    ds_read_b128 v[140:143], v27 offset:2048
    ds_read_b128 v[136:139], v27 offset:2560
    ds_read_b128 v[132:135], v27 offset:3072
    ds_read_b128 v[128:131], v27 offset:3584
    ds_read_b128 v[100:103], v26 offset:512
    ds_read_b128 v[104:107], v26 offset:1024
    ds_read_b128 v[108:111], v26 offset:1536
    ds_read_b128 v[112:115], v26 offset:2048
    ds_read_b128 v[116:119], v26 offset:2560
    ds_read_b128 v[120:123], v26 offset:3072
    ds_read_b128 v[124:127], v26 offset:3584
    s_or_b32 s61, s65, s56
    s_cmp_lg_u32 s61, 0
    s_cbranch_scc1 L_nobump_44
    s_add_u32 s61, s58, 16
    v_mov_b32 v228, s61
    v_mov_b32 v229, 0
    s_mov_b64 exec, 1
    buffer_store_dword v228, v229, s[44:47], s4 offen
    s_mov_b64 exec, -1
L_nobump_44:
    s_cmp_lg_u32 s56, 3
    s_cbranch_scc1 L_w3_45
    s_mul_i32 s13, s64, 294912
    s_add_u32 s13, s13, 4718592
    buffer_load_dword v230, v231, s[44:47], s13 offen sc1
    v_mov_b32 v227, 1073741824
    v_cmp_gt_u32 vcc, 32768, v231
    s_add_u32 s13, s13, 262144
    s_nop 0
    v_cndmask_b32 v227, v227, v231, vcc
    buffer_load_dword v230, v227, s[44:47], s13 offen sc1
    s_lshl_b32 s13, s65, 6
    v_add_u32 v227, s13, v1
    v_mul_u32_u24 v227, 1152, v227
    s_mul_i32 s13, s64, 144
    buffer_load_dword v230, v227, s[36:39], s13 offen
    buffer_load_dword v230, v227, s[36:39], s13 offen offset:140
    s_mov_b32 s24, s20
    s_mov_b32 s25, s21
    s_mov_b32 s26, 663552
    s_mov_b32 s27, 0x20000
    s_mov_b32 s13, 0
    buffer_load_dword v230, v231, s[24:27], s13 offen
    s_mov_b32 s13, 262144
    buffer_load_dword v230, v231, s[24:27], s13 offen
    s_mov_b32 s13, 524288
    buffer_load_dword v230, v231, s[24:27], s13 offen
L_w3_45:
    s_waitcnt lgkmcnt(15)
    v_readfirstlane_b32 s60, v224
    s_add_u32 s61, s58, 9
    s_cmp_lg_u32 s60, 0
    s_cselect_b32 s59, s61, s59
    s_cmp_eq_u32 s69, 0
    s_cbranch_scc1 L_convd_47
L_conv_46:
    s_waitcnt lgkmcnt(4)
    v_mfma_f32_16x16x32_bf16 v[60:63], v[156:159], v[96:99], v[60:63]
    v_mfma_f32_16x16x32_bf16 v[56:59], v[152:155], v[96:99], v[56:59]
    v_mfma_f32_16x16x32_bf16 v[52:55], v[148:151], v[96:99], v[52:55]
    v_mfma_f32_16x16x32_bf16 v[48:51], v[144:147], v[96:99], v[48:51]
    v_mfma_f32_16x16x32_bf16 v[44:47], v[140:143], v[96:99], v[44:47]
    ds_read_b128 v[236:239], v27 offset:64
    v_mfma_f32_16x16x32_bf16 v[40:43], v[136:139], v[96:99], v[40:43]
    v_mfma_f32_16x16x32_bf16 v[36:39], v[132:135], v[96:99], v[36:39]
    ds_read_b128 v[232:235], v27 offset:576
    v_mfma_f32_16x16x32_bf16 v[32:35], v[128:131], v[96:99], v[32:35]
    ds_read_b128 v[96:99], v26 offset:64
    v_mfma_f32_16x16x32_bf16 v[60:63], v[152:155], v[100:103], v[60:63]
    v_mfma_f32_16x16x32_bf16 v[56:59], v[148:151], v[100:103], v[56:59]
    v_mfma_f32_16x16x32_bf16 v[52:55], v[144:147], v[100:103], v[52:55]
    v_mfma_f32_16x16x32_bf16 v[48:51], v[140:143], v[100:103], v[48:51]
    ds_read_b128 v[216:219], v27 offset:1088
    v_mfma_f32_16x16x32_bf16 v[44:47], v[136:139], v[100:103], v[44:47]
    v_mfma_f32_16x16x32_bf16 v[40:43], v[132:135], v[100:103], v[40:43]
    ds_read_b128 v[212:215], v27 offset:1600
    v_mfma_f32_16x16x32_bf16 v[36:39], v[128:131], v[100:103], v[36:39]
    ds_read_b128 v[100:103], v26 offset:576
    v_mfma_f32_16x16x32_bf16 v[60:63], v[148:151], v[104:107], v[60:63]
    v_mfma_f32_16x16x32_bf16 v[56:59], v[144:147], v[104:107], v[56:59]
    v_mfma_f32_16x16x32_bf16 v[52:55], v[140:143], v[104:107], v[52:55]
    ds_read_b128 v[208:211], v27 offset:2112
    v_mfma_f32_16x16x32_bf16 v[48:51], v[136:139], v[104:107], v[48:51]
    v_mfma_f32_16x16x32_bf16 v[44:47], v[132:135], v[104:107], v[44:47]
    ds_read_b128 v[204:207], v27 offset:2624
    v_mfma_f32_16x16x32_bf16 v[40:43], v[128:131], v[104:107], v[40:43]
    ds_read_b128 v[104:107], v26 offset:1088
    v_mfma_f32_16x16x32_bf16 v[60:63], v[144:147], v[108:111], v[60:63]
    v_mfma_f32_16x16x32_bf16 v[56:59], v[140:143], v[108:111], v[56:59]
    ds_read_b128 v[200:203], v27 offset:3136
    v_mfma_f32_16x16x32_bf16 v[52:55], v[136:139], v[108:111], v[52:55]
    v_mfma_f32_16x16x32_bf16 v[48:51], v[132:135], v[108:111], v[48:51]
    ds_read_b128 v[196:199], v27 offset:3648
    v_mfma_f32_16x16x32_bf16 v[44:47], v[128:131], v[108:111], v[44:47]
    ds_read_b128 v[108:111], v26 offset:1600
    s_waitcnt lgkmcnt(12)
    v_mfma_f32_16x16x32_bf16 v[60:63], v[140:143], v[112:115], v[60:63]
    v_mfma_f32_16x16x32_bf16 v[56:59], v[136:139], v[112:115], v[56:59]
    v_mfma_f32_16x16x32_bf16 v[52:55], v[132:135], v[112:115], v[52:55]
    v_mfma_f32_16x16x32_bf16 v[48:51], v[128:131], v[112:115], v[48:51]
    ds_read_b128 v[112:115], v26 offset:2112
    v_mfma_f32_16x16x32_bf16 v[60:63], v[136:139], v[116:119], v[60:63]
    v_mfma_f32_16x16x32_bf16 v[56:59], v[132:135], v[116:119], v[56:59]
    v_mfma_f32_16x16x32_bf16 v[52:55], v[128:131], v[116:119], v[52:55]
    ds_read_b128 v[116:119], v26 offset:2624
    v_mfma_f32_16x16x32_bf16 v[60:63], v[132:135], v[120:123], v[60:63]
    v_mfma_f32_16x16x32_bf16 v[56:59], v[128:131], v[120:123], v[56:59]
    ds_read_b128 v[120:123], v26 offset:3136
    v_mfma_f32_16x16x32_bf16 v[60:63], v[128:131], v[124:127], v[60:63]
    ds_read_b128 v[124:127], v26 offset:3648
    s_waitcnt lgkmcnt(4)
    v_mfma_f32_16x16x32_bf16 v[60:63], v[236:239], v[96:99], v[60:63]
    v_mfma_f32_16x16x32_bf16 v[56:59], v[232:235], v[96:99], v[56:59]
    s_sub_u32 s69, s69, 1
    s_cmp_eq_u32 s69, 0
    s_cselect_b32 s61, 16128, 0
    s_add_u32 s61, s61, 128
    s_cmp_eq_u32 s69, 0
    s_cselect_b32 s62, 8768, 0
    s_add_u32 s62, s62, 128
    v_add_u32 v26, s61, v26
    v_add_u32 v27, s62, v27
    v_mfma_f32_16x16x32_bf16 v[52:55], v[216:219], v[96:99], v[52:55]
    v_mfma_f32_16x16x32_bf16 v[48:51], v[212:215], v[96:99], v[48:51]
    v_mfma_f32_16x16x32_bf16 v[44:47], v[208:211], v[96:99], v[44:47]
    ds_read_b128 v[156:159], v27 offset:0
    v_mfma_f32_16x16x32_bf16 v[40:43], v[204:207], v[96:99], v[40:43]
    v_mfma_f32_16x16x32_bf16 v[36:39], v[200:203], v[96:99], v[36:39]
    ds_read_b128 v[152:155], v27 offset:512
    v_mfma_f32_16x16x32_bf16 v[32:35], v[196:199], v[96:99], v[32:35]
    ds_read_b128 v[96:99], v26 offset:0
    v_mfma_f32_16x16x32_bf16 v[60:63], v[232:235], v[100:103], v[60:63]
    v_mfma_f32_16x16x32_bf16 v[56:59], v[216:219], v[100:103], v[56:59]
    v_mfma_f32_16x16x32_bf16 v[52:55], v[212:215], v[100:103], v[52:55]
    v_mfma_f32_16x16x32_bf16 v[48:51], v[208:211], v[100:103], v[48:51]
    ds_read_b128 v[148:151], v27 offset:1024
    v_mfma_f32_16x16x32_bf16 v[44:47], v[204:207], v[100:103], v[44:47]
    v_mfma_f32_16x16x32_bf16 v[40:43], v[200:203], v[100:103], v[40:43]
    ds_read_b128 v[144:147], v27 offset:1536
    v_mfma_f32_16x16x32_bf16 v[36:39], v[196:199], v[100:103], v[36:39]
    ds_read_b128 v[100:103], v26 offset:512
    v_mfma_f32_16x16x32_bf16 v[60:63], v[216:219], v[104:107], v[60:63]
    v_mfma_f32_16x16x32_bf16 v[56:59], v[212:215], v[104:107], v[56:59]
    v_mfma_f32_16x16x32_bf16 v[52:55], v[208:211], v[104:107], v[52:55]
    ds_read_b128 v[140:143], v27 offset:2048
    v_mfma_f32_16x16x32_bf16 v[48:51], v[204:207], v[104:107], v[48:51]
    v_mfma_f32_16x16x32_bf16 v[44:47], v[200:203], v[104:107], v[44:47]
    ds_read_b128 v[136:139], v27 offset:2560
    v_mfma_f32_16x16x32_bf16 v[40:43], v[196:199], v[104:107], v[40:43]
    ds_read_b128 v[104:107], v26 offset:1024
    v_mfma_f32_16x16x32_bf16 v[60:63], v[212:215], v[108:111], v[60:63]
    v_mfma_f32_16x16x32_bf16 v[56:59], v[208:211], v[108:111], v[56:59]
    ds_read_b128 v[132:135], v27 offset:3072
    v_mfma_f32_16x16x32_bf16 v[52:55], v[204:207], v[108:111], v[52:55]
    v_mfma_f32_16x16x32_bf16 v[48:51], v[200:203], v[108:111], v[48:51]
    ds_read_b128 v[128:131], v27 offset:3584
    v_mfma_f32_16x16x32_bf16 v[44:47], v[196:199], v[108:111], v[44:47]
    ds_read_b128 v[108:111], v26 offset:1536
    s_waitcnt lgkmcnt(12)
    v_mfma_f32_16x16x32_bf16 v[60:63], v[208:211], v[112:115], v[60:63]
    v_mfma_f32_16x16x32_bf16 v[56:59], v[204:207], v[112:115], v[56:59]
    v_mfma_f32_16x16x32_bf16 v[52:55], v[200:203], v[112:115], v[52:55]
    v_mfma_f32_16x16x32_bf16 v[48:51], v[196:199], v[112:115], v[48:51]
    ds_read_b128 v[112:115], v26 offset:2048
    v_mfma_f32_16x16x32_bf16 v[60:63], v[204:207], v[116:119], v[60:63]
    v_mfma_f32_16x16x32_bf16 v[56:59], v[200:203], v[116:119], v[56:59]
    v_mfma_f32_16x16x32_bf16 v[52:55], v[196:199], v[116:119], v[52:55]
    ds_read_b128 v[116:119], v26 offset:2560
    v_mfma_f32_16x16x32_bf16 v[60:63], v[200:203], v[120:123], v[60:63]
    v_mfma_f32_16x16x32_bf16 v[56:59], v[196:199], v[120:123], v[56:59]
    ds_read_b128 v[120:123], v26 offset:3072
    v_mfma_f32_16x16x32_bf16 v[60:63], v[196:199], v[124:127], v[60:63]
    ds_read_b128 v[124:127], v26 offset:3584
    s_cmp_lg_u32 s69, 0
    s_cbranch_scc1 L_conv_46
L_convd_47:
    s_cmp_eq_u32 s10, 0
    s_cbranch_scc1 L_convd_49
L_conv_48:
    s_waitcnt lgkmcnt(4)
    v_mfma_f32_16x16x32_bf16 v[92:95], v[156:159], v[96:99], v[92:95]
    v_mfma_f32_16x16x32_bf16 v[88:91], v[152:155], v[96:99], v[88:91]
    v_mfma_f32_16x16x32_bf16 v[84:87], v[148:151], v[96:99], v[84:87]
    v_mfma_f32_16x16x32_bf16 v[80:83], v[144:147], v[96:99], v[80:83]
    v_mfma_f32_16x16x32_bf16 v[76:79], v[140:143], v[96:99], v[76:79]
    ds_read_b128 v[236:239], v27 offset:64
    v_mfma_f32_16x16x32_bf16 v[72:75], v[136:139], v[96:99], v[72:75]
    v_mfma_f32_16x16x32_bf16 v[68:71], v[132:135], v[96:99], v[68:71]
    ds_read_b128 v[232:235], v27 offset:576
    v_mfma_f32_16x16x32_bf16 v[64:67], v[128:131], v[96:99], v[64:67]
    ds_read_b128 v[96:99], v26 offset:64
    v_mfma_f32_16x16x32_bf16 v[92:95], v[152:155], v[100:103], v[92:95]
    v_mfma_f32_16x16x32_bf16 v[88:91], v[148:151], v[100:103], v[88:91]
    v_mfma_f32_16x16x32_bf16 v[84:87], v[144:147], v[100:103], v[84:87]
    v_mfma_f32_16x16x32_bf16 v[80:83], v[140:143], v[100:103], v[80:83]
    ds_read_b128 v[216:219], v27 offset:1088
    v_mfma_f32_16x16x32_bf16 v[76:79], v[136:139], v[100:103], v[76:79]
    v_mfma_f32_16x16x32_bf16 v[72:75], v[132:135], v[100:103], v[72:75]
    ds_read_b128 v[212:215], v27 offset:1600
    v_mfma_f32_16x16x32_bf16 v[68:71], v[128:131], v[100:103], v[68:71]
    ds_read_b128 v[100:103], v26 offset:576
    v_mfma_f32_16x16x32_bf16 v[92:95], v[148:151], v[104:107], v[92:95]
    v_mfma_f32_16x16x32_bf16 v[88:91], v[144:147], v[104:107], v[88:91]
    v_mfma_f32_16x16x32_bf16 v[84:87], v[140:143], v[104:107], v[84:87]
    ds_read_b128 v[208:211], v27 offset:2112
    v_mfma_f32_16x16x32_bf16 v[80:83], v[136:139], v[104:107], v[80:83]
    v_mfma_f32_16x16x32_bf16 v[76:79], v[132:135], v[104:107], v[76:79]
    ds_read_b128 v[204:207], v27 offset:2624
    v_mfma_f32_16x16x32_bf16 v[72:75], v[128:131], v[104:107], v[72:75]
    ds_read_b128 v[104:107], v26 offset:1088
    v_mfma_f32_16x16x32_bf16 v[92:95], v[144:147], v[108:111], v[92:95]
    v_mfma_f32_16x16x32_bf16 v[88:91], v[140:143], v[108:111], v[88:91]
    ds_read_b128 v[200:203], v27 offset:3136
    v_mfma_f32_16x16x32_bf16 v[84:87], v[136:139], v[108:111], v[84:87]
    v_mfma_f32_16x16x32_bf16 v[80:83], v[132:135], v[108:111], v[80:83]
    ds_read_b128 v[196:199], v27 offset:3648
    v_mfma_f32_16x16x32_bf16 v[76:79], v[128:131], v[108:111], v[76:79]
    ds_read_b128 v[108:111], v26 offset:1600
    s_waitcnt lgkmcnt(12)
    v_mfma_f32_16x16x32_bf16 v[92:95], v[140:143], v[112:115], v[92:95]
    v_mfma_f32_16x16x32_bf16 v[88:91], v[136:139], v[112:115], v[88:91]
    v_mfma_f32_16x16x32_bf16 v[84:87], v[132:135], v[112:115], v[84:87]
    v_mfma_f32_16x16x32_bf16 v[80:83], v[128:131], v[112:115], v[80:83]
    ds_read_b128 v[112:115], v26 offset:2112
    v_mfma_f32_16x16x32_bf16 v[92:95], v[136:139], v[116:119], v[92:95]
    v_mfma_f32_16x16x32_bf16 v[88:91], v[132:135], v[116:119], v[88:91]
    v_mfma_f32_16x16x32_bf16 v[84:87], v[128:131], v[116:119], v[84:87]
    ds_read_b128 v[116:119], v26 offset:2624
    v_mfma_f32_16x16x32_bf16 v[92:95], v[132:135], v[120:123], v[92:95]
    v_mfma_f32_16x16x32_bf16 v[88:91], v[128:131], v[120:123], v[88:91]
    ds_read_b128 v[120:123], v26 offset:3136
    v_mfma_f32_16x16x32_bf16 v[92:95], v[128:131], v[124:127], v[92:95]
    ds_read_b128 v[124:127], v26 offset:3648
    s_waitcnt lgkmcnt(4)
    v_mfma_f32_16x16x32_bf16 v[92:95], v[236:239], v[96:99], v[92:95]
    v_mfma_f32_16x16x32_bf16 v[88:91], v[232:235], v[96:99], v[88:91]
    s_sub_u32 s10, s10, 1
    v_add_u32 v26, 128, v26
    v_add_u32 v27, 128, v27
    v_mfma_f32_16x16x32_bf16 v[84:87], v[216:219], v[96:99], v[84:87]
    v_mfma_f32_16x16x32_bf16 v[80:83], v[212:215], v[96:99], v[80:83]
    v_mfma_f32_16x16x32_bf16 v[76:79], v[208:211], v[96:99], v[76:79]
    ds_read_b128 v[156:159], v27 offset:0
    v_mfma_f32_16x16x32_bf16 v[72:75], v[204:207], v[96:99], v[72:75]
    v_mfma_f32_16x16x32_bf16 v[68:71], v[200:203], v[96:99], v[68:71]
    ds_read_b128 v[152:155], v27 offset:512
    v_mfma_f32_16x16x32_bf16 v[64:67], v[196:199], v[96:99], v[64:67]
    ds_read_b128 v[96:99], v26 offset:0
    v_mfma_f32_16x16x32_bf16 v[92:95], v[232:235], v[100:103], v[92:95]
    v_mfma_f32_16x16x32_bf16 v[88:91], v[216:219], v[100:103], v[88:91]
    v_mfma_f32_16x16x32_bf16 v[84:87], v[212:215], v[100:103], v[84:87]
    v_mfma_f32_16x16x32_bf16 v[80:83], v[208:211], v[100:103], v[80:83]
    ds_read_b128 v[148:151], v27 offset:1024
    v_mfma_f32_16x16x32_bf16 v[76:79], v[204:207], v[100:103], v[76:79]
    v_mfma_f32_16x16x32_bf16 v[72:75], v[200:203], v[100:103], v[72:75]
    ds_read_b128 v[144:147], v27 offset:1536
    v_mfma_f32_16x16x32_bf16 v[68:71], v[196:199], v[100:103], v[68:71]
    ds_read_b128 v[100:103], v26 offset:512
    v_mfma_f32_16x16x32_bf16 v[92:95], v[216:219], v[104:107], v[92:95]
    v_mfma_f32_16x16x32_bf16 v[88:91], v[212:215], v[104:107], v[88:91]
    v_mfma_f32_16x16x32_bf16 v[84:87], v[208:211], v[104:107], v[84:87]
    ds_read_b128 v[140:143], v27 offset:2048
    v_mfma_f32_16x16x32_bf16 v[80:83], v[204:207], v[104:107], v[80:83]
    v_mfma_f32_16x16x32_bf16 v[76:79], v[200:203], v[104:107], v[76:79]
    ds_read_b128 v[136:139], v27 offset:2560
    v_mfma_f32_16x16x32_bf16 v[72:75], v[196:199], v[104:107], v[72:75]
    ds_read_b128 v[104:107], v26 offset:1024
    v_mfma_f32_16x16x32_bf16 v[92:95], v[212:215], v[108:111], v[92:95]
    v_mfma_f32_16x16x32_bf16 v[88:91], v[208:211], v[108:111], v[88:91]
    ds_read_b128 v[132:135], v27 offset:3072
    v_mfma_f32_16x16x32_bf16 v[84:87], v[204:207], v[108:111], v[84:87]
    v_mfma_f32_16x16x32_bf16 v[80:83], v[200:203], v[108:111], v[80:83]
    ds_read_b128 v[128:131], v27 offset:3584
    v_mfma_f32_16x16x32_bf16 v[76:79], v[196:199], v[108:111], v[76:79]
    ds_read_b128 v[108:111], v26 offset:1536
    s_waitcnt lgkmcnt(12)
    v_mfma_f32_16x16x32_bf16 v[92:95], v[208:211], v[112:115], v[92:95]
    v_mfma_f32_16x16x32_bf16 v[88:91], v[204:207], v[112:115], v[88:91]
    v_mfma_f32_16x16x32_bf16 v[84:87], v[200:203], v[112:115], v[84:87]
    v_mfma_f32_16x16x32_bf16 v[80:83], v[196:199], v[112:115], v[80:83]
    ds_read_b128 v[112:115], v26 offset:2048
    v_mfma_f32_16x16x32_bf16 v[92:95], v[204:207], v[116:119], v[92:95]
    v_mfma_f32_16x16x32_bf16 v[88:91], v[200:203], v[116:119], v[88:91]
    v_mfma_f32_16x16x32_bf16 v[84:87], v[196:199], v[116:119], v[84:87]
    ds_read_b128 v[116:119], v26 offset:2560
    v_mfma_f32_16x16x32_bf16 v[92:95], v[200:203], v[120:123], v[92:95]
    v_mfma_f32_16x16x32_bf16 v[88:91], v[196:199], v[120:123], v[88:91]
    ds_read_b128 v[120:123], v26 offset:3072
    v_mfma_f32_16x16x32_bf16 v[92:95], v[196:199], v[124:127], v[92:95]
    ds_read_b128 v[124:127], v26 offset:3584
    s_cmp_lg_u32 s10, 0
    s_cbranch_scc1 L_conv_48
L_convd_49:
    v_add_u32 v226, s11, v221
    v_add_u32 v20, 8192, v20
    v_add_u32 v21, 8192, v21
    v_add_u32 v227, s11, v222
    s_add_u32 s11, s12, 6144
    s_cmp_lg_u32 s95, 0
    s_cselect_b64 vcc, -1, 0
    s_cselect_b32 s61, 0, 2048
    s_add_u32 s12, s12, s61
    s_waitcnt lgkmcnt(0)
    s_barrier
    s_cmp_lt_u32 s56, 2
    s_cbranch_scc1 L_noq_50
    s_mul_i32 s61, s56, 5120
    s_add_u32 s61, s61, s22
    s_add_u32 m0, s61, 49936
    s_nop 0
    buffer_load_dwordx4 v2, s[36:39], 0 offen lds
    s_add_u32 m0, m0, 1024
    s_nop 0
    buffer_load_dwordx4 v3, s[36:39], 0 offen lds
    s_add_u32 m0, m0, 1024
    s_nop 0
    buffer_load_dwordx4 v4, s[36:39], 0 offen lds
    s_add_u32 m0, m0, 1024
    s_nop 0
    buffer_load_dwordx4 v5, s[36:39], 0 offen lds
    s_add_u32 m0, m0, 1024
    s_nop 0
    buffer_load_dwordx4 v6, s[36:39], 0 offen lds
L_noq_50:
    s_cbranch_vccnz L_seg_51
    ds_write_b128 v226, v[48:51] offset:4096
    ds_write_b128 v226, v[52:55] offset:5120
    ds_write_b128 v226, v[56:59] offset:6144
    ds_write_b128 v226, v[60:63] offset:7168
    s_branch L_seg_52
L_seg_51:
    ds_write_b128 v226, v[32:35] offset:0
    ds_write_b128 v226, v[36:39] offset:1024
    ds_write_b128 v226, v[40:43] offset:2048
    ds_write_b128 v226, v[44:47] offset:3072
L_seg_52:
    s_cmp_eq_u32 s97, 0
    s_cbranch_scc1 L_seg_53
    ds_write_b128 v226, v[80:83] offset:12288
    ds_write_b128 v226, v[84:87] offset:13312
    ds_write_b128 v226, v[88:91] offset:14336
    ds_write_b128 v226, v[92:95] offset:15360
L_seg_53:
    v_add_u32 v13, -128, v13
    s_waitcnt lgkmcnt(0)
    s_barrier
    s_cbranch_vccnz L_seg_54
    ds_read_b128 v[96:99], v226 offset:0
    ds_read_b128 v[100:103], v226 offset:1024
    ds_read_b128 v[104:107], v226 offset:2048
    ds_read_b128 v[108:111], v226 offset:3072
    s_waitcnt lgkmcnt(0)
    v_pk_add_f32 v[96:97], v[96:97], v[32:33]
    v_pk_add_f32 v[98:99], v[98:99], v[34:35]
    v_cvt_pk_bf16_f32 v96, v97, v96
    v_cvt_pk_bf16_f32 v97, v99, v98
    ds_write_b32 v227, v96 offset:1600
    ds_write_b32 v227, v97 offset:1536
    v_pk_add_f32 v[100:101], v[100:101], v[36:37]
    v_pk_add_f32 v[102:103], v[102:103], v[38:39]
    v_cvt_pk_bf16_f32 v100, v101, v100
    v_cvt_pk_bf16_f32 v101, v103, v102
    ds_write_b32 v227, v100 offset:1088
    ds_write_b32 v227, v101 offset:1024
    v_pk_add_f32 v[104:105], v[104:105], v[40:41]
    v_pk_add_f32 v[106:107], v[106:107], v[42:43]
    v_cvt_pk_bf16_f32 v104, v105, v104
    v_cvt_pk_bf16_f32 v105, v107, v106
    ds_write_b32 v227, v104 offset:576
    ds_write_b32 v227, v105 offset:512
    v_pk_add_f32 v[108:109], v[108:109], v[44:45]
    v_pk_add_f32 v[110:111], v[110:111], v[46:47]
    v_cvt_pk_bf16_f32 v108, v109, v108
    v_cvt_pk_bf16_f32 v109, v111, v110
    ds_write_b32 v227, v108 offset:64
    ds_write_b32 v227, v109 offset:0
    s_waitcnt lgkmcnt(0)
    ds_read_b128 v[128:131], v226 offset:0
    ds_read_b128 v[132:135], v226 offset:1024
    s_branch L_seg_55
L_seg_54:
    ds_read_b128 v[96:99], v226 offset:4096
    ds_read_b128 v[100:103], v226 offset:5120
    ds_read_b128 v[104:107], v226 offset:6144
    ds_read_b128 v[108:111], v226 offset:7168
    s_waitcnt lgkmcnt(0)
    v_pk_add_f32 v[96:97], v[96:97], v[48:49]
    v_pk_add_f32 v[98:99], v[98:99], v[50:51]
    v_cvt_pk_bf16_f32 v96, v97, v96
    v_cvt_pk_bf16_f32 v97, v99, v98
    ds_write_b32 v227, v96 offset:5696
    ds_write_b32 v227, v97 offset:5632
    v_pk_add_f32 v[100:101], v[100:101], v[52:53]
    v_pk_add_f32 v[102:103], v[102:103], v[54:55]
    v_cvt_pk_bf16_f32 v100, v101, v100
    v_cvt_pk_bf16_f32 v101, v103, v102
    ds_write_b32 v227, v100 offset:5184
    ds_write_b32 v227, v101 offset:5120
    v_pk_add_f32 v[104:105], v[104:105], v[56:57]
    v_pk_add_f32 v[106:107], v[106:107], v[58:59]
    v_cvt_pk_bf16_f32 v104, v105, v104
    v_cvt_pk_bf16_f32 v105, v107, v106
    ds_write_b32 v227, v104 offset:4672
    ds_write_b32 v227, v105 offset:4608
    v_pk_add_f32 v[108:109], v[108:109], v[60:61]
    v_pk_add_f32 v[110:111], v[110:111], v[62:63]
    v_cvt_pk_bf16_f32 v108, v109, v108
    v_cvt_pk_bf16_f32 v109, v111, v110
    ds_write_b32 v227, v108 offset:4160
    ds_write_b32 v227, v109 offset:4096
    s_waitcnt lgkmcnt(0)
    ds_read_b128 v[128:131], v226 offset:4096
    ds_read_b128 v[132:135], v226 offset:5120
L_seg_55:
    s_cmp_eq_u32 s97, 0
    s_cbranch_scc1 L_seg_56
    ds_read_b128 v[112:115], v226 offset:8192
    ds_read_b128 v[116:119], v226 offset:9216
    ds_read_b128 v[120:123], v226 offset:10240
    ds_read_b128 v[124:127], v226 offset:11264
    s_waitcnt lgkmcnt(0)
    v_pk_add_f32 v[112:113], v[112:113], v[64:65]
    v_pk_add_f32 v[114:115], v[114:115], v[66:67]
    v_cvt_pk_bf16_f32 v112, v113, v112
    v_cvt_pk_bf16_f32 v113, v115, v114
    ds_write_b32 v227, v112 offset:9792
    ds_write_b32 v227, v113 offset:9728
    v_pk_add_f32 v[116:117], v[116:117], v[68:69]
    v_pk_add_f32 v[118:119], v[118:119], v[70:71]
    v_cvt_pk_bf16_f32 v116, v117, v116
    v_cvt_pk_bf16_f32 v117, v119, v118
    ds_write_b32 v227, v116 offset:9280
    ds_write_b32 v227, v117 offset:9216
    v_pk_add_f32 v[120:121], v[120:121], v[72:73]
    v_pk_add_f32 v[122:123], v[122:123], v[74:75]
    v_cvt_pk_bf16_f32 v120, v121, v120
    v_cvt_pk_bf16_f32 v121, v123, v122
    ds_write_b32 v227, v120 offset:8768
    ds_write_b32 v227, v121 offset:8704
    v_pk_add_f32 v[124:125], v[124:125], v[76:77]
    v_pk_add_f32 v[126:127], v[126:127], v[78:79]
    v_cvt_pk_bf16_f32 v124, v125, v124
    v_cvt_pk_bf16_f32 v125, v127, v126
    ds_write_b32 v227, v124 offset:8256
    ds_write_b32 v227, v125 offset:8192
    s_waitcnt lgkmcnt(0)
    ds_read_b128 v[136:139], v226 offset:8192
    ds_read_b128 v[140:143], v226 offset:9216
L_seg_56:
    s_cmp_lg_u32 s60, 0
    s_cbranch_scc1 L_pslow_57
    s_waitcnt lgkmcnt(0)
    buffer_store_dwordx4 v[128:131], v30, s[44:47], s12 offen offset:0 nt
    buffer_store_dwordx4 v[132:135], v30, s[44:47], s12 offen offset:1024 nt
    s_cmp_eq_u32 s97, 0
    s_cbranch_scc1 L_ys_59
    buffer_store_dwordx4 v[136:139], v30, s[44:47], s11 offen offset:0 nt
    buffer_store_dwordx4 v[140:143], v30, s[44:47], s11 offen offset:1024 nt
L_ys_59:
    v_mov_b32 v226, s59
    s_waitcnt vmcnt(0)
    s_mov_b64 exec, 1
    buffer_store_dword v226, v20, s[44:47], 0 offen
    s_mov_b64 exec, -1
    s_branch L_pdone_58
L_pslow_57:
    s_waitcnt lgkmcnt(0)
    buffer_store_dwordx4 v[128:131], v30, s[44:47], s12 offen offset:0 sc1
    buffer_store_dwordx4 v[132:135], v30, s[44:47], s12 offen offset:1024 sc1
    s_cmp_eq_u32 s97, 0
    s_cbranch_scc1 L_ys_60
    buffer_store_dwordx4 v[136:139], v30, s[44:47], s11 offen offset:0 sc1
    buffer_store_dwordx4 v[140:143], v30, s[44:47], s11 offen offset:1024 sc1
L_ys_60:
    v_mov_b32 v226, s59
    s_waitcnt vmcnt(0)
    s_mov_b64 exec, 1
    buffer_store_dword v226, v20, s[44:47], s60 offen sc1
    s_mov_b64 exec, -1
L_pdone_58:
    s_barrier
    ds_read_b128 v[184:187], v13
    ds_read_b128 v[188:191], v13 offset:64
    ds_read_b128 v[192:195], v14
    s_mov_b32 s95, 0
    s_cmp_eq_u32 s56, 3
    s_cbranch_scc1 L_noy_61
    buffer_load_dwordx4 v[208:211], v21, s[44:47], s60 offen sc1
    s_waitcnt vmcnt(0)
    v_xor_b32 v208, s59, v208
    v_xor_b32 v209, s59, v209
    v_xor_b32 v210, s59, v210
    v_xor_b32 v211, s59, v211
    v_or3_b32 v208, v208, v209, v210
    v_or_b32 v208, v208, v211
    v_cmp_ne_u32 vcc, 0, v208
    s_cbranch_vccnz L_noy_61
    buffer_load_dwordx4 v[148:151], v10, s[44:47], 0 offen sc1
    buffer_load_dwordx4 v[152:155], v10, s[44:47], s6 offen sc1
    buffer_load_dwordx4 v[156:159], v10, s[44:47], s7 offen sc1
    s_mov_b32 s95, 1
L_noy_61:
    s_waitcnt lgkmcnt(0)
    v_lshlrev_b32 v32, 16, v184
    v_and_b32 v33, 0xffff0000, v184
    v_pk_mul_f32 v[56:57], v[172:173], v[32:33]
    v_lshlrev_b32 v34, 16, v185
    v_and_b32 v35, 0xffff0000, v185
    v_pk_mul_f32 v[58:59], v[174:175], v[34:35]
    v_lshlrev_b32 v36, 16, v186
    v_and_b32 v37, 0xffff0000, v186
    v_pk_mul_f32 v[60:61], v[176:177], v[36:37]
    v_lshlrev_b32 v38, 16, v187
    v_and_b32 v39, 0xffff0000, v187
    v_pk_mul_f32 v[62:63], v[178:179], v[38:39]
    v_lshlrev_b32 v40, 16, v188
    v_and_b32 v41, 0xffff0000, v188
    v_pk_mul_f32 v[64:65], v[180:181], v[40:41]
    v_lshlrev_b32 v42, 16, v189
    v_and_b32 v43, 0xffff0000, v189
    v_pk_mul_f32 v[66:67], v[182:183], v[42:43]
    v_lshlrev_b32 v44, 16, v190
    v_and_b32 v45, 0xffff0000, v190
    v_pk_mul_f32 v[68:69], v[242:243], v[44:45]
    v_lshlrev_b32 v46, 16, v191
    v_and_b32 v47, 0xffff0000, v191
    v_pk_mul_f32 v[70:71], v[244:245], v[46:47]
    v_lshlrev_b32 v48, 16, v192
    v_and_b32 v49, 0xffff0000, v192
    v_pk_mul_f32 v[72:73], v[246:247], v[48:49]
    v_lshlrev_b32 v50, 16, v193
    v_and_b32 v51, 0xffff0000, v193
    v_pk_mul_f32 v[74:75], v[248:249], v[50:51]
    v_lshlrev_b32 v52, 16, v194
    v_and_b32 v53, 0xffff0000, v194
    v_pk_mul_f32 v[76:77], v[250:251], v[52:53]
    v_lshlrev_b32 v54, 16, v195
    v_and_b32 v55, 0xffff0000, v195
    v_pk_mul_f32 v[78:79], v[252:253], v[54:55]
    s_cmp_eq_u32 s56, 3
    s_cbranch_scc1 L_w3_62
    s_cmp_lg_u32 s95, 0
    s_cbranch_scc1 L_goty_63
    s_mov_b32 s63, 6
    buffer_load_dwordx4 v[208:211], v21, s[44:47], s60 offen sc1
    s_sleep 3
L_fp_65:
    buffer_load_dwordx4 v[212:215], v21, s[44:47], s60 offen sc1
    s_waitcnt vmcnt(1)
    v_xor_b32 v208, s59, v208
    v_xor_b32 v209, s59, v209
    v_xor_b32 v210, s59, v210
    v_xor_b32 v211, s59, v211
    v_or3_b32 v208, v208, v209, v210
    v_or_b32 v208, v208, v211
    v_cmp_ne_u32 vcc, 0, v208
    s_cbranch_vccz L_got3_64
    buffer_load_dwordx4 v[208:211], v21, s[44:47], s60 offen sc1
    s_sub_u32 s63, s63, 1
    s_waitcnt vmcnt(1)
    v_xor_b32 v212, s59, v212
    v_xor_b32 v213, s59, v213
    v_xor_b32 v214, s59, v214
    v_xor_b32 v215, s59, v215
    v_or3_b32 v212, v212, v213, v214
    v_or_b32 v212, v212, v215
    v_cmp_ne_u32 vcc, 0, v212
    s_cbranch_vccz L_got3_64
    s_cmp_lg_u32 s63, 0
    s_cbranch_scc1 L_fp_65
    s_waitcnt vmcnt(0)
    s_mov_b32 s63, 524288
L_poll_66:
    buffer_load_dwordx4 v[208:211], v21, s[44:47], s60 offen sc1
    s_sub_u32 s63, s63, 1
    s_waitcnt vmcnt(0)
    v_xor_b32 v208, s59, v208
    v_xor_b32 v209, s59, v209
    v_xor_b32 v210, s59, v210
    v_xor_b32 v211, s59, v211
    v_or3_b32 v208, v208, v209, v210
    v_or_b32 v208, v208, v211
    v_cmp_ne_u32 vcc, 0, v208
    s_cbranch_vccz L_polld_67
    s_sleep 2
    s_cmp_lg_u32 s63, 0
    s_cbranch_scc1 L_poll_66
L_polld_67:
L_got3_64:
    buffer_load_dwordx4 v[148:151], v10, s[44:47], 0 offen sc1
    buffer_load_dwordx4 v[152:155], v10, s[44:47], s6 offen sc1
    buffer_load_dwordx4 v[156:159], v10, s[44:47], s7 offen sc1
L_goty_63:
    s_waitcnt vmcnt(2)
    ds_write_b128 v9, v[148:151] offset:0
    s_waitcnt vmcnt(1)
    ds_write_b128 v9, v[152:155] offset:1152
    s_waitcnt vmcnt(0)
    ds_write_b128 v9, v[156:159] offset:2304
L_w3_62:
    s_waitcnt lgkmcnt(0)
    s_barrier
    ds_read_b64_tr_b16 v[160:161], v11 offset:0
    ds_read_b64_tr_b16 v[162:163], v11 offset:576
    ds_read_b64_tr_b16 v[164:165], v11 offset:4608
    ds_read_b64_tr_b16 v[166:167], v11 offset:5184
    ds_read_b64_tr_b16 v[168:169], v12 offset:0
    ds_read_b64_tr_b16 v[170:171], v12 offset:576
    s_waitcnt lgkmcnt(4)
    v_lshlrev_b32 v224, 16, v160
    v_and_b32 v225, 0xffff0000, v160
    v_pk_fma_f32 v[224:225], v[224:225], v[32:33], v[56:57]
    v_cvt_pk_bf16_f32 v184, v224, v225
    v_lshlrev_b32 v226, 16, v161
    v_and_b32 v227, 0xffff0000, v161
    v_pk_fma_f32 v[226:227], v[226:227], v[34:35], v[58:59]
    v_cvt_pk_bf16_f32 v185, v226, v227
    v_lshlrev_b32 v224, 16, v162
    v_and_b32 v225, 0xffff0000, v162
    v_pk_fma_f32 v[224:225], v[224:225], v[36:37], v[60:61]
    v_cvt_pk_bf16_f32 v186, v224, v225
    v_lshlrev_b32 v226, 16, v163
    v_and_b32 v227, 0xffff0000, v163
    v_pk_fma_f32 v[226:227], v[226:227], v[38:39], v[62:63]
    v_cvt_pk_bf16_f32 v187, v226, v227
    ds_write_b128 v13, v[184:187] offset:0
    s_waitcnt lgkmcnt(3)
    v_lshlrev_b32 v224, 16, v164
    v_and_b32 v225, 0xffff0000, v164
    v_pk_fma_f32 v[224:225], v[224:225], v[40:41], v[64:65]
    v_cvt_pk_bf16_f32 v188, v224, v225
    v_lshlrev_b32 v226, 16, v165
    v_and_b32 v227, 0xffff0000, v165
    v_pk_fma_f32 v[226:227], v[226:227], v[42:43], v[66:67]
    v_cvt_pk_bf16_f32 v189, v226, v227
    v_lshlrev_b32 v224, 16, v166
    v_and_b32 v225, 0xffff0000, v166
    v_pk_fma_f32 v[224:225], v[224:225], v[44:45], v[68:69]
    v_cvt_pk_bf16_f32 v190, v224, v225
    v_lshlrev_b32 v226, 16, v167
    v_and_b32 v227, 0xffff0000, v167
    v_pk_fma_f32 v[226:227], v[226:227], v[46:47], v[70:71]
    v_cvt_pk_bf16_f32 v191, v226, v227
    ds_write_b128 v13, v[188:191] offset:64
    s_waitcnt lgkmcnt(2)
    v_lshlrev_b32 v224, 16, v168
    v_and_b32 v225, 0xffff0000, v168
    v_pk_fma_f32 v[224:225], v[224:225], v[48:49], v[72:73]
    v_cvt_pk_bf16_f32 v192, v224, v225
    v_lshlrev_b32 v226, 16, v169
    v_and_b32 v227, 0xffff0000, v169
    v_pk_fma_f32 v[226:227], v[226:227], v[50:51], v[74:75]
    v_cvt_pk_bf16_f32 v193, v226, v227
    v_lshlrev_b32 v224, 16, v170
    v_and_b32 v225, 0xffff0000, v170
    v_pk_fma_f32 v[224:225], v[224:225], v[52:53], v[76:77]
    v_cvt_pk_bf16_f32 v194, v224, v225
    v_lshlrev_b32 v226, 16, v171
    v_and_b32 v227, 0xffff0000, v171
    v_pk_fma_f32 v[226:227], v[226:227], v[54:55], v[78:79]
    v_cvt_pk_bf16_f32 v195, v226, v227
    s_mov_b64 exec, 0xffff
    ds_write_b128 v14, v[192:195] offset:0
    s_mov_b64 exec, -1
    s_waitcnt lgkmcnt(0)
    ds_read_b128 v[160:163], v241 offset:0
    ds_read_b128 v[164:167], v241 offset:1024
    ds_read_b128 v[168:171], v241 offset:2048
    s_waitcnt lgkmcnt(2)
    buffer_store_dwordx4 v[160:163], v28, s[40:43], 0 offen nt
    s_waitcnt lgkmcnt(1)
    buffer_store_dwordx4 v[164:167], v29, s[40:43], 0 offen nt
    s_waitcnt lgkmcnt(0)
    s_mov_b64 exec, 0xffff
    buffer_store_dwordx4 v[168:171], v240, s[40:43], 0 offen nt
L_end:
    s_endpgm
.section .rodata,"a"
.p2align 6
.amdhsa_kernel concat_heads__ssm_conv_h3__sliding_local_dilated__prompt_kernel
  .amdhsa_next_free_vgpr 256
  .amdhsa_next_free_sgpr 102
  .amdhsa_accum_offset 256
  .amdhsa_group_segment_fixed_size 0
  .amdhsa_kernarg_size 96
  .amdhsa_user_sgpr_count 2
  .amdhsa_user_sgpr_kernarg_segment_ptr 1
  .amdhsa_system_sgpr_workgroup_id_x 1
.end_amdhsa_kernel
```
